```python
import torch

def _softmax(x, axis=-1):
    return torch.softmax(x, dim=axis)
def _gelu(x):
    return torch.nn.functional.gelu(x, approximate="tanh")
def _silu(x):
    return torch.nn.functional.silu(x)
def _sigmoid(x):
    return torch.sigmoid(x)
def _layernorm(x, axis=-1, eps=1e-5):
    m = x.mean(dim=axis, keepdim=True)
    v = x.var(dim=axis, keepdim=True, unbiased=False)
    return (x - m) / torch.sqrt(v + eps)
def _scatter_add(tgt, idx, src, axis=0):
    return tgt.clone().index_add_(axis, idx, src)
def _segment_sum(src, seg, n):
    out = torch.zeros((n,) + src.shape[1:], dtype=src.dtype)
    return out.index_add_(0, seg, src)
def _pad(x, pw):
    flat = tuple(v for pair in reversed(pw) for v in pair)
    return torch.nn.functional.pad(x, flat)

kernel_name = 'sequential_preLN__sliding_local_dilated__swiglu_ffn__prompt'

def setup_inputs():

    _w = (lambda a: (lambda t: t.to(torch.bfloat16) if t.is_floating_point() else t)(torch.as_tensor(a)))
    def _A_setup():
        B, S, D = 1, 2048, 448
        return {
            "x": _w((lambda *s: torch.randn(*s, dtype=torch.bfloat16) * 0.05)(B, S, D)),
            "wqkv": _w((lambda *s: torch.randn(*s, dtype=torch.bfloat16) * 0.05)(D, 3 * D)),
            "wo": _w((lambda *s: torch.randn(*s, dtype=torch.bfloat16) * 0.05)(D, D)),
        }
    _A_in = _A_setup()

    def _B_setup():
        B, S, D, F = 1, 2048, 448, 1792
        return {
            "x": _w((lambda *s: torch.randn(*s, dtype=torch.bfloat16) * 0.05)(B, S, D)),
            "w_gate": _w((lambda *s: torch.randn(*s, dtype=torch.bfloat16) * 0.05)(D, F)),
            "w_up": _w((lambda *s: torch.randn(*s, dtype=torch.bfloat16) * 0.05)(D, F)),
            "w_down": _w((lambda *s: torch.randn(*s, dtype=torch.bfloat16) * 0.05)(F, D)),
        }
    _B_in = _B_setup()

    return {
        "A_x": _A_in["x"],
        "A_wqkv": _A_in["wqkv"],
        "A_wo": _A_in["wo"],
        "B_x": _B_in["x"],
        "B_w_gate": _B_in["w_gate"],
        "B_w_up": _B_in["w_up"],
        "B_w_down": _B_in["w_down"],
    }

def reference(A_x, A_wqkv, A_wo, B_x, B_w_gate, B_w_up, B_w_down):
    def _A_ref(x, wqkv, wo):
        B, S, D = x.shape
        H = 16; Dh = D // H
        W, dil = 8, 2
        qkv = (lambda x, *d: x.permute(*d))((x @ wqkv).reshape(B, S, 3, H, Dh), 2, 0, 3, 1, 4)
        q, k, v = qkv[0], qkv[1], qkv[2]
        scale = Dh ** -0.5
        pos = torch.arange(S)
        off = torch.arange(W) * dil
        idx = pos[:, None] - off[None, :]
        mask = idx >= 0
        idx_c = torch.where(mask, idx, 0).reshape(-1)
        kg = k[:, :, idx_c, :].reshape(B, H, S, W, Dh)
        vg = v[:, :, idx_c, :].reshape(B, H, S, W, Dh)
        logits = torch.einsum("bhsd,bhswd->bhsw", q, kg) * scale
        logits = torch.where(mask[None, None, :, :], logits, -1e9)
        attn = _softmax(logits, axis=-1)
        o = torch.einsum("bhsw,bhswd->bhsd", attn, vg)
        return (lambda x, *d: x.permute(*d))(o, 0, 2, 1, 3).reshape(B, S, D) @ wo

    def _B_ref(x, w_gate, w_up, w_down):
        g = _silu(x @ w_gate)
        u = x @ w_up
        return (g * u) @ w_down

    x = A_x
    h = x + _A_ref(_layernorm(x, axis=-1), A_wqkv, A_wo)
    h2 = h + _B_ref(_layernorm(h, axis=-1), B_w_gate, B_w_up, B_w_down)
    return h2
```

```asm
; @launch kernel=k1_kernel grid=(224,1,1) block=(512,1,1) lds=163840
; @launch kernel=k2_kernel grid=(256,1,1) block=(512,1,1) lds=140288
; @launch kernel=k3_kernel grid=(224,1,1) block=(512,1,1) lds=163840
; @launch kernel=k4_kernel grid=(224,1,1) block=(512,1,1) lds=131072
.amdgcn_target "amdgcn-amd-amdhsa--gfx950"
.text
.globl k1_kernel
.p2align 8
.type k1_kernel,@function
k1_kernel:
    s_load_dwordx2 s[4:5], s[0:1], 0
    s_load_dwordx2 s[6:7], s[0:1], 8
    s_load_dwordx2 s[20:21], s[0:1], 72
    s_cmp_ge_u32 s2, 224
    s_cbranch_scc1 k1_kernel_end
    v_lshrrev_b32 v2, 6, v0
    v_and_b32 v1, 63, v0
    s_nop 0
    v_readfirstlane_b32 s3, v2
    s_waitcnt lgkmcnt(0)
    s_mov_b32 s8, s4
    s_mov_b32 s9, s5
    s_mov_b32 s10, 0x1c0000
    s_mov_b32 s11, 0x00020000
    s_mov_b32 s12, s6
    s_mov_b32 s13, s7
    s_mov_b32 s14, 0x126000
    s_mov_b32 s15, 0x00020000
    s_mov_b32 s16, s20
    s_mov_b32 s17, s21
    s_mov_b32 s18, 0x540000
    s_mov_b32 s19, 0x00020000
    s_and_b32 s24, s2, 7
    s_lshr_b32 s25, s2, 3
    s_mul_i32 s26, s25, 37
    s_lshr_b32 s26, s26, 8
    s_mul_i32 s27, s26, 7
    s_sub_u32 s27, s25, s27
    s_lshl_b32 s24, s24, 2
    s_add_u32 s24, s24, s26
    s_lshl_b32 s36, s24, 6
    s_and_b32 s34, s3, 1
    s_lshr_b32 s35, s3, 1
    s_lshl_b32 s37, s34, 5
    s_add_u32 s28, s36, s37
    v_cmp_le_u32 vcc, 24, v1
    v_subrev_u32 v3, 24, v1
    s_nop 0
    v_cndmask_b32 v3, v1, v3, vcc
    v_cndmask_b32 v2, 0, 1, vcc
    v_mul_u32_u24 v2, 2688, v2
    s_and_b32 s38, s3, 2
    v_xor_b32 v3, s38, v3
    v_lshl_add_u32 v2, v3, 4, v2
    s_mul_i32 s38, s27, 384
    s_mul_i32 s39, s3, 10752
    s_add_u32 s38, s38, s39
    s_mul_i32 s39, s3, 1536
    v_lshrrev_b32 v5, 4, v1
    v_bfe_u32 v6, v1, 2, 2
    v_lshl_add_u32 v5, v5, 3, v6
    v_mul_u32_u24 v5, 384, v5
    v_and_b32 v6, 3, v1
    v_lshl_add_u32 v5, v6, 3, v5
    s_mul_i32 s29, s35, 96
    v_bfe_u32 v8, v1, 4, 1
    v_lshlrev_b32 v8, 5, v8
    v_and_b32 v9, 31, v5
    v_sub_u32 v10, v5, v9
    v_add_u32 v11, 0, v9
    v_add_u32 v11, s29, v11
    v_xor_b32 v11, v8, v11
    v_add_u32 v12, v10, v11
    v_add_u32 v11, 32, v9
    v_add_u32 v11, s29, v11
    v_xor_b32 v11, v8, v11
    v_add_u32 v6, v10, v11
    v_add_u32 v11, 64, v9
    v_add_u32 v11, s29, v11
    v_xor_b32 v11, v8, v11
    v_add_u32 v7, v10, v11
    v_mov_b32 v5, v12
    v_add_u32 v152, 65536, v5
    v_add_u32 v155, 131072, v5
    v_add_u32 v153, 65536, v6
    v_add_u32 v156, 131072, v6
    v_add_u32 v154, 65536, v7
    v_add_u32 v157, 131072, v7
    v_lshlrev_b32 v4, 4, v1
    s_mul_i32 s30, s3, 8
    s_add_u32 s31, s36, s30
    s_mul_i32 s31, s31, 896
    s_mul_i32 s30, s30, 912
    s_mov_b32 exec_hi, 0x00ffffff
    s_mov_b32 m0, s30
    s_nop 0
    buffer_load_dwordx4 v4, s[8:11], s31 offen lds
    s_add_u32 s30, s30, 912
    s_add_u32 s31, s31, 896
    s_mov_b32 m0, s30
    s_nop 0
    buffer_load_dwordx4 v4, s[8:11], s31 offen lds
    s_add_u32 s30, s30, 912
    s_add_u32 s31, s31, 896
    s_mov_b32 m0, s30
    s_nop 0
    buffer_load_dwordx4 v4, s[8:11], s31 offen lds
    s_add_u32 s30, s30, 912
    s_add_u32 s31, s31, 896
    s_mov_b32 m0, s30
    s_nop 0
    buffer_load_dwordx4 v4, s[8:11], s31 offen lds
    s_add_u32 s30, s30, 912
    s_add_u32 s31, s31, 896
    s_mov_b32 m0, s30
    s_nop 0
    buffer_load_dwordx4 v4, s[8:11], s31 offen lds
    s_add_u32 s30, s30, 912
    s_add_u32 s31, s31, 896
    s_mov_b32 m0, s30
    s_nop 0
    buffer_load_dwordx4 v4, s[8:11], s31 offen lds
    s_add_u32 s30, s30, 912
    s_add_u32 s31, s31, 896
    s_mov_b32 m0, s30
    s_nop 0
    buffer_load_dwordx4 v4, s[8:11], s31 offen lds
    s_add_u32 s30, s30, 912
    s_add_u32 s31, s31, 896
    s_mov_b32 m0, s30
    s_nop 0
    buffer_load_dwordx4 v4, s[8:11], s31 offen lds
    s_add_u32 s30, s30, 912
    s_add_u32 s31, s31, 896
    s_mov_b32 exec_hi, -1
    s_mov_b32 exec_hi, 0xffff
    s_add_u32 s30, s39, 65536
    s_mov_b32 m0, s30
    s_add_u32 s31, s38, 0
    buffer_load_dwordx4 v2, s[12:15], s31 offen lds
    s_add_u32 s30, s39, 66304
    s_mov_b32 m0, s30
    s_add_u32 s31, s38, 5376
    buffer_load_dwordx4 v2, s[12:15], s31 offen lds
    s_mov_b32 exec_hi, -1
    s_mov_b32 exec_hi, 0xffff
    s_add_u32 s30, s39, 77824
    s_mov_b32 m0, s30
    s_add_u32 s31, s38, 86016
    buffer_load_dwordx4 v2, s[12:15], s31 offen lds
    s_add_u32 s30, s39, 78592
    s_mov_b32 m0, s30
    s_add_u32 s31, s38, 91392
    buffer_load_dwordx4 v2, s[12:15], s31 offen lds
    s_mov_b32 exec_hi, -1
    s_mov_b32 exec_hi, 0xffff
    s_add_u32 s30, s39, 90112
    s_mov_b32 m0, s30
    s_add_u32 s31, s38, 172032
    buffer_load_dwordx4 v2, s[12:15], s31 offen lds
    s_add_u32 s30, s39, 90880
    s_mov_b32 m0, s30
    s_add_u32 s31, s38, 177408
    buffer_load_dwordx4 v2, s[12:15], s31 offen lds
    s_mov_b32 exec_hi, -1
    s_mov_b32 exec_hi, 0xffff
    s_add_u32 s30, s39, 102400
    s_mov_b32 m0, s30
    s_add_u32 s31, s38, 258048
    buffer_load_dwordx4 v2, s[12:15], s31 offen lds
    s_add_u32 s30, s39, 103168
    s_mov_b32 m0, s30
    s_add_u32 s31, s38, 263424
    buffer_load_dwordx4 v2, s[12:15], s31 offen lds
    s_mov_b32 exec_hi, -1
    s_mov_b32 exec_hi, 0xffff
    s_add_u32 s30, s39, 114688
    s_mov_b32 m0, s30
    s_add_u32 s31, s38, 344064
    buffer_load_dwordx4 v2, s[12:15], s31 offen lds
    s_add_u32 s30, s39, 115456
    s_mov_b32 m0, s30
    s_add_u32 s31, s38, 349440
    buffer_load_dwordx4 v2, s[12:15], s31 offen lds
    s_mov_b32 exec_hi, -1
    s_mov_b32 exec_hi, 0xffff
    s_add_u32 s30, s39, 126976
    s_mov_b32 m0, s30
    s_add_u32 s31, s38, 430080
    buffer_load_dwordx4 v2, s[12:15], s31 offen lds
    s_add_u32 s30, s39, 127744
    s_mov_b32 m0, s30
    s_add_u32 s31, s38, 435456
    buffer_load_dwordx4 v2, s[12:15], s31 offen lds
    s_mov_b32 exec_hi, -1
    s_mov_b32 exec_hi, 0xffff
    s_add_u32 s30, s39, 139264
    s_mov_b32 m0, s30
    s_add_u32 s31, s38, 516096
    buffer_load_dwordx4 v2, s[12:15], s31 offen lds
    s_add_u32 s30, s39, 140032
    s_mov_b32 m0, s30
    s_add_u32 s31, s38, 521472
    buffer_load_dwordx4 v2, s[12:15], s31 offen lds
    s_mov_b32 exec_hi, -1
    s_mov_b32 exec_hi, 0xffff
    s_add_u32 s30, s39, 151552
    s_mov_b32 m0, s30
    s_add_u32 s31, s38, 602112
    buffer_load_dwordx4 v2, s[12:15], s31 offen lds
    s_add_u32 s30, s39, 152320
    s_mov_b32 m0, s30
    s_add_u32 s31, s38, 607488
    buffer_load_dwordx4 v2, s[12:15], s31 offen lds
    s_mov_b32 exec_hi, -1
    v_accvgpr_write_b32 a0, 0
    v_accvgpr_write_b32 a1, 0
    v_accvgpr_write_b32 a2, 0
    v_accvgpr_write_b32 a3, 0
    v_accvgpr_write_b32 a4, 0
    v_accvgpr_write_b32 a5, 0
    v_accvgpr_write_b32 a6, 0
    v_accvgpr_write_b32 a7, 0
    v_accvgpr_write_b32 a8, 0
    v_accvgpr_write_b32 a9, 0
    v_accvgpr_write_b32 a10, 0
    v_accvgpr_write_b32 a11, 0
    v_accvgpr_write_b32 a12, 0
    v_accvgpr_write_b32 a13, 0
    v_accvgpr_write_b32 a14, 0
    v_accvgpr_write_b32 a15, 0
    v_accvgpr_write_b32 a16, 0
    v_accvgpr_write_b32 a17, 0
    v_accvgpr_write_b32 a18, 0
    v_accvgpr_write_b32 a19, 0
    v_accvgpr_write_b32 a20, 0
    v_accvgpr_write_b32 a21, 0
    v_accvgpr_write_b32 a22, 0
    v_accvgpr_write_b32 a23, 0
    v_and_b32 v3, 15, v1
    v_add_u32 v3, s37, v3
    v_mul_u32_u24 v3, 912, v3
    v_lshrrev_b32 v4, 4, v1
    v_lshl_add_u32 v3, v4, 4, v3
    s_waitcnt vmcnt(16)
    s_barrier
    v_lshrrev_b32 v8, 3, v1
    s_mul_i32 s30, s3, 8
    v_add_u32 v8, s30, v8
    v_mul_u32_u24 v8, 912, v8
    v_and_b32 v9, 7, v1
    v_mul_u32_u24 v9, 112, v9
    v_add_u32 v8, v8, v9
    s_mov_b32 s40, 0x3f803f80
    ds_read_b128 v[16:19], v8 offset:0
    ds_read_b128 v[20:23], v8 offset:16
    ds_read_b128 v[24:27], v8 offset:32
    ds_read_b128 v[28:31], v8 offset:48
    ds_read_b128 v[32:35], v8 offset:64
    ds_read_b128 v[36:39], v8 offset:80
    ds_read_b128 v[40:43], v8 offset:96
    v_mov_b32 v48, 0
    v_mov_b32 v49, 0
    v_mov_b32 v50, 0
    v_mov_b32 v51, 0
    s_waitcnt lgkmcnt(0)
    v_dot2_f32_bf16 v48, v16, s40, v48
    v_dot2_f32_bf16 v50, v16, v16, v50
    v_dot2_f32_bf16 v49, v17, s40, v49
    v_dot2_f32_bf16 v51, v17, v17, v51
    v_dot2_f32_bf16 v48, v18, s40, v48
    v_dot2_f32_bf16 v50, v18, v18, v50
    v_dot2_f32_bf16 v49, v19, s40, v49
    v_dot2_f32_bf16 v51, v19, v19, v51
    v_dot2_f32_bf16 v48, v20, s40, v48
    v_dot2_f32_bf16 v50, v20, v20, v50
    v_dot2_f32_bf16 v49, v21, s40, v49
    v_dot2_f32_bf16 v51, v21, v21, v51
    v_dot2_f32_bf16 v48, v22, s40, v48
    v_dot2_f32_bf16 v50, v22, v22, v50
    v_dot2_f32_bf16 v49, v23, s40, v49
    v_dot2_f32_bf16 v51, v23, v23, v51
    v_dot2_f32_bf16 v48, v24, s40, v48
    v_dot2_f32_bf16 v50, v24, v24, v50
    v_dot2_f32_bf16 v49, v25, s40, v49
    v_dot2_f32_bf16 v51, v25, v25, v51
    v_dot2_f32_bf16 v48, v26, s40, v48
    v_dot2_f32_bf16 v50, v26, v26, v50
    v_dot2_f32_bf16 v49, v27, s40, v49
    v_dot2_f32_bf16 v51, v27, v27, v51
    v_dot2_f32_bf16 v48, v28, s40, v48
    v_dot2_f32_bf16 v50, v28, v28, v50
    v_dot2_f32_bf16 v49, v29, s40, v49
    v_dot2_f32_bf16 v51, v29, v29, v51
    v_dot2_f32_bf16 v48, v30, s40, v48
    v_dot2_f32_bf16 v50, v30, v30, v50
    v_dot2_f32_bf16 v49, v31, s40, v49
    v_dot2_f32_bf16 v51, v31, v31, v51
    v_dot2_f32_bf16 v48, v32, s40, v48
    v_dot2_f32_bf16 v50, v32, v32, v50
    v_dot2_f32_bf16 v49, v33, s40, v49
    v_dot2_f32_bf16 v51, v33, v33, v51
    v_dot2_f32_bf16 v48, v34, s40, v48
    v_dot2_f32_bf16 v50, v34, v34, v50
    v_dot2_f32_bf16 v49, v35, s40, v49
    v_dot2_f32_bf16 v51, v35, v35, v51
    v_dot2_f32_bf16 v48, v36, s40, v48
    v_dot2_f32_bf16 v50, v36, v36, v50
    v_dot2_f32_bf16 v49, v37, s40, v49
    v_dot2_f32_bf16 v51, v37, v37, v51
    v_dot2_f32_bf16 v48, v38, s40, v48
    v_dot2_f32_bf16 v50, v38, v38, v50
    v_dot2_f32_bf16 v49, v39, s40, v49
    v_dot2_f32_bf16 v51, v39, v39, v51
    v_dot2_f32_bf16 v48, v40, s40, v48
    v_dot2_f32_bf16 v50, v40, v40, v50
    v_dot2_f32_bf16 v49, v41, s40, v49
    v_dot2_f32_bf16 v51, v41, v41, v51
    v_dot2_f32_bf16 v48, v42, s40, v48
    v_dot2_f32_bf16 v50, v42, v42, v50
    v_dot2_f32_bf16 v49, v43, s40, v49
    v_dot2_f32_bf16 v51, v43, v43, v51
    s_nop 3
    v_add_f32 v48, v48, v49
    v_add_f32 v50, v50, v51
    s_nop 1
    v_add_f32_dpp v49, v48, v48 quad_perm:[1,0,3,2] row_mask:0xf bank_mask:0xf
    v_add_f32_dpp v51, v50, v50 quad_perm:[1,0,3,2] row_mask:0xf bank_mask:0xf
    v_mov_b32 v48, v49
    v_mov_b32 v50, v51
    s_nop 1
    v_add_f32_dpp v49, v48, v48 quad_perm:[2,3,0,1] row_mask:0xf bank_mask:0xf
    v_add_f32_dpp v51, v50, v50 quad_perm:[2,3,0,1] row_mask:0xf bank_mask:0xf
    v_mov_b32 v48, v49
    v_mov_b32 v50, v51
    s_nop 1
    v_add_f32_dpp v49, v48, v48 row_half_mirror row_mask:0xf bank_mask:0xf
    v_add_f32_dpp v51, v50, v50 row_half_mirror row_mask:0xf bank_mask:0xf
    v_mov_b32 v48, v49
    v_mov_b32 v50, v51
    v_mul_f32 v52, 0x3b124925, v48
    v_mul_f32 v50, 0x3b124925, v50
    v_fma_f32 v50, -v52, v52, v50
    v_add_f32 v50, 0x3727c5ac, v50
    v_rsq_f32 v53, v50
    s_nop 0
    v_mul_f32 v52, v52, v53
    v_sub_f32 v52, 0, v52
    v_lshlrev_b32 v54, 16, v16
    v_and_b32 v55, 0xffff0000, v16
    v_fma_f32 v54, v54, v53, v52
    v_fma_f32 v55, v55, v53, v52
    v_cvt_pk_bf16_f32 v16, v54, v55
    v_lshlrev_b32 v54, 16, v17
    v_and_b32 v55, 0xffff0000, v17
    v_fma_f32 v54, v54, v53, v52
    v_fma_f32 v55, v55, v53, v52
    v_cvt_pk_bf16_f32 v17, v54, v55
    v_lshlrev_b32 v54, 16, v18
    v_and_b32 v55, 0xffff0000, v18
    v_fma_f32 v54, v54, v53, v52
    v_fma_f32 v55, v55, v53, v52
    v_cvt_pk_bf16_f32 v18, v54, v55
    v_lshlrev_b32 v54, 16, v19
    v_and_b32 v55, 0xffff0000, v19
    v_fma_f32 v54, v54, v53, v52
    v_fma_f32 v55, v55, v53, v52
    v_cvt_pk_bf16_f32 v19, v54, v55
    v_lshlrev_b32 v54, 16, v20
    v_and_b32 v55, 0xffff0000, v20
    v_fma_f32 v54, v54, v53, v52
    v_fma_f32 v55, v55, v53, v52
    v_cvt_pk_bf16_f32 v20, v54, v55
    v_lshlrev_b32 v54, 16, v21
    v_and_b32 v55, 0xffff0000, v21
    v_fma_f32 v54, v54, v53, v52
    v_fma_f32 v55, v55, v53, v52
    v_cvt_pk_bf16_f32 v21, v54, v55
    v_lshlrev_b32 v54, 16, v22
    v_and_b32 v55, 0xffff0000, v22
    v_fma_f32 v54, v54, v53, v52
    v_fma_f32 v55, v55, v53, v52
    v_cvt_pk_bf16_f32 v22, v54, v55
    v_lshlrev_b32 v54, 16, v23
    v_and_b32 v55, 0xffff0000, v23
    v_fma_f32 v54, v54, v53, v52
    v_fma_f32 v55, v55, v53, v52
    v_cvt_pk_bf16_f32 v23, v54, v55
    v_lshlrev_b32 v54, 16, v24
    v_and_b32 v55, 0xffff0000, v24
    v_fma_f32 v54, v54, v53, v52
    v_fma_f32 v55, v55, v53, v52
    v_cvt_pk_bf16_f32 v24, v54, v55
    v_lshlrev_b32 v54, 16, v25
    v_and_b32 v55, 0xffff0000, v25
    v_fma_f32 v54, v54, v53, v52
    v_fma_f32 v55, v55, v53, v52
    v_cvt_pk_bf16_f32 v25, v54, v55
    v_lshlrev_b32 v54, 16, v26
    v_and_b32 v55, 0xffff0000, v26
    v_fma_f32 v54, v54, v53, v52
    v_fma_f32 v55, v55, v53, v52
    v_cvt_pk_bf16_f32 v26, v54, v55
    v_lshlrev_b32 v54, 16, v27
    v_and_b32 v55, 0xffff0000, v27
    v_fma_f32 v54, v54, v53, v52
    v_fma_f32 v55, v55, v53, v52
    v_cvt_pk_bf16_f32 v27, v54, v55
    v_lshlrev_b32 v54, 16, v28
    v_and_b32 v55, 0xffff0000, v28
    v_fma_f32 v54, v54, v53, v52
    v_fma_f32 v55, v55, v53, v52
    v_cvt_pk_bf16_f32 v28, v54, v55
    v_lshlrev_b32 v54, 16, v29
    v_and_b32 v55, 0xffff0000, v29
    v_fma_f32 v54, v54, v53, v52
    v_fma_f32 v55, v55, v53, v52
    v_cvt_pk_bf16_f32 v29, v54, v55
    v_lshlrev_b32 v54, 16, v30
    v_and_b32 v55, 0xffff0000, v30
    v_fma_f32 v54, v54, v53, v52
    v_fma_f32 v55, v55, v53, v52
    v_cvt_pk_bf16_f32 v30, v54, v55
    v_lshlrev_b32 v54, 16, v31
    v_and_b32 v55, 0xffff0000, v31
    v_fma_f32 v54, v54, v53, v52
    v_fma_f32 v55, v55, v53, v52
    v_cvt_pk_bf16_f32 v31, v54, v55
    v_lshlrev_b32 v54, 16, v32
    v_and_b32 v55, 0xffff0000, v32
    v_fma_f32 v54, v54, v53, v52
    v_fma_f32 v55, v55, v53, v52
    v_cvt_pk_bf16_f32 v32, v54, v55
    v_lshlrev_b32 v54, 16, v33
    v_and_b32 v55, 0xffff0000, v33
    v_fma_f32 v54, v54, v53, v52
    v_fma_f32 v55, v55, v53, v52
    v_cvt_pk_bf16_f32 v33, v54, v55
    v_lshlrev_b32 v54, 16, v34
    v_and_b32 v55, 0xffff0000, v34
    v_fma_f32 v54, v54, v53, v52
    v_fma_f32 v55, v55, v53, v52
    v_cvt_pk_bf16_f32 v34, v54, v55
    v_lshlrev_b32 v54, 16, v35
    v_and_b32 v55, 0xffff0000, v35
    v_fma_f32 v54, v54, v53, v52
    v_fma_f32 v55, v55, v53, v52
    v_cvt_pk_bf16_f32 v35, v54, v55
    v_lshlrev_b32 v54, 16, v36
    v_and_b32 v55, 0xffff0000, v36
    v_fma_f32 v54, v54, v53, v52
    v_fma_f32 v55, v55, v53, v52
    v_cvt_pk_bf16_f32 v36, v54, v55
    v_lshlrev_b32 v54, 16, v37
    v_and_b32 v55, 0xffff0000, v37
    v_fma_f32 v54, v54, v53, v52
    v_fma_f32 v55, v55, v53, v52
    v_cvt_pk_bf16_f32 v37, v54, v55
    v_lshlrev_b32 v54, 16, v38
    v_and_b32 v55, 0xffff0000, v38
    v_fma_f32 v54, v54, v53, v52
    v_fma_f32 v55, v55, v53, v52
    v_cvt_pk_bf16_f32 v38, v54, v55
    v_lshlrev_b32 v54, 16, v39
    v_and_b32 v55, 0xffff0000, v39
    v_fma_f32 v54, v54, v53, v52
    v_fma_f32 v55, v55, v53, v52
    v_cvt_pk_bf16_f32 v39, v54, v55
    v_lshlrev_b32 v54, 16, v40
    v_and_b32 v55, 0xffff0000, v40
    v_fma_f32 v54, v54, v53, v52
    v_fma_f32 v55, v55, v53, v52
    v_cvt_pk_bf16_f32 v40, v54, v55
    v_lshlrev_b32 v54, 16, v41
    v_and_b32 v55, 0xffff0000, v41
    v_fma_f32 v54, v54, v53, v52
    v_fma_f32 v55, v55, v53, v52
    v_cvt_pk_bf16_f32 v41, v54, v55
    v_lshlrev_b32 v54, 16, v42
    v_and_b32 v55, 0xffff0000, v42
    v_fma_f32 v54, v54, v53, v52
    v_fma_f32 v55, v55, v53, v52
    v_cvt_pk_bf16_f32 v42, v54, v55
    v_lshlrev_b32 v54, 16, v43
    v_and_b32 v55, 0xffff0000, v43
    v_fma_f32 v54, v54, v53, v52
    v_fma_f32 v55, v55, v53, v52
    v_cvt_pk_bf16_f32 v43, v54, v55
    ds_write_b128 v8, v[16:19] offset:0
    ds_write_b128 v8, v[20:23] offset:16
    ds_write_b128 v8, v[24:27] offset:32
    ds_write_b128 v8, v[28:31] offset:48
    ds_write_b128 v8, v[32:35] offset:64
    ds_write_b128 v8, v[36:39] offset:80
    ds_write_b128 v8, v[40:43] offset:96
    s_waitcnt lgkmcnt(0)
    s_barrier
    ds_read_b128 v[16:19], v3 offset:0
    ds_read_b128 v[20:23], v3 offset:64
    ds_read_b128 v[24:27], v3 offset:128
    ds_read_b128 v[28:31], v3 offset:192
    ds_read_b128 v[32:35], v3 offset:256
    ds_read_b128 v[36:39], v3 offset:320
    ds_read_b128 v[40:43], v3 offset:384
    ds_read_b128 v[44:47], v3 offset:448
    ds_read_b128 v[48:51], v3 offset:512
    ds_read_b128 v[52:55], v3 offset:576
    ds_read_b128 v[56:59], v3 offset:640
    ds_read_b128 v[60:63], v3 offset:704
    ds_read_b128 v[64:67], v3 offset:768
    ds_read_b128 v[68:71], v3 offset:832
    ds_read_b128 v[72:75], v3 offset:14592
    ds_read_b128 v[76:79], v3 offset:14656
    ds_read_b128 v[80:83], v3 offset:14720
    ds_read_b128 v[84:87], v3 offset:14784
    ds_read_b128 v[88:91], v3 offset:14848
    ds_read_b128 v[92:95], v3 offset:14912
    ds_read_b128 v[96:99], v3 offset:14976
    ds_read_b128 v[100:103], v3 offset:15040
    ds_read_b128 v[104:107], v3 offset:15104
    ds_read_b128 v[108:111], v3 offset:15168
    ds_read_b128 v[112:115], v3 offset:15232
    ds_read_b128 v[116:119], v3 offset:15296
    ds_read_b128 v[120:123], v3 offset:15360
    ds_read_b128 v[124:127], v3 offset:15424
    s_waitcnt lgkmcnt(0)
    s_barrier
    s_mov_b32 exec_hi, 0xffff
    s_add_u32 s30, s39, 0
    s_mov_b32 m0, s30
    s_add_u32 s31, s38, 688128
    buffer_load_dwordx4 v2, s[12:15], s31 offen lds
    s_add_u32 s30, s39, 768
    s_mov_b32 m0, s30
    s_add_u32 s31, s38, 693504
    buffer_load_dwordx4 v2, s[12:15], s31 offen lds
    s_mov_b32 exec_hi, -1
    s_mov_b32 exec_hi, 0xffff
    s_add_u32 s30, s39, 12288
    s_mov_b32 m0, s30
    s_add_u32 s31, s38, 774144
    buffer_load_dwordx4 v2, s[12:15], s31 offen lds
    s_add_u32 s30, s39, 13056
    s_mov_b32 m0, s30
    s_add_u32 s31, s38, 779520
    buffer_load_dwordx4 v2, s[12:15], s31 offen lds
    s_mov_b32 exec_hi, -1
    s_mov_b32 exec_hi, 0xffff
    s_add_u32 s30, s39, 24576
    s_mov_b32 m0, s30
    s_add_u32 s31, s38, 860160
    buffer_load_dwordx4 v2, s[12:15], s31 offen lds
    s_add_u32 s30, s39, 25344
    s_mov_b32 m0, s30
    s_add_u32 s31, s38, 865536
    buffer_load_dwordx4 v2, s[12:15], s31 offen lds
    s_mov_b32 exec_hi, -1
    s_mov_b32 exec_hi, 0xffff
    s_add_u32 s30, s39, 36864
    s_mov_b32 m0, s30
    s_add_u32 s31, s38, 946176
    buffer_load_dwordx4 v2, s[12:15], s31 offen lds
    s_add_u32 s30, s39, 37632
    s_mov_b32 m0, s30
    s_add_u32 s31, s38, 951552
    buffer_load_dwordx4 v2, s[12:15], s31 offen lds
    s_mov_b32 exec_hi, -1
    s_mov_b32 exec_hi, 0xffff
    s_add_u32 s30, s39, 49152
    s_mov_b32 m0, s30
    s_add_u32 s31, s38, 1032192
    buffer_load_dwordx4 v2, s[12:15], s31 offen lds
    s_add_u32 s30, s39, 49920
    s_mov_b32 m0, s30
    s_add_u32 s31, s38, 1037568
    buffer_load_dwordx4 v2, s[12:15], s31 offen lds
    s_mov_b32 exec_hi, -1
    s_waitcnt vmcnt(10)
    s_barrier
    ds_read_b64_tr_b16 v[128:129], v152 offset:0
    ds_read_b64_tr_b16 v[130:131], v152 offset:1536
    ds_read_b64_tr_b16 v[132:133], v153 offset:0
    ds_read_b64_tr_b16 v[134:135], v153 offset:1536
    ds_read_b64_tr_b16 v[136:137], v154 offset:0
    ds_read_b64_tr_b16 v[138:139], v154 offset:1536
    s_waitcnt lgkmcnt(4)
    v_mfma_f32_16x16x32_bf16 a[0:3], v[128:131], v[16:19], a[0:3]
    v_mfma_f32_16x16x32_bf16 a[12:15], v[128:131], v[72:75], a[12:15]
    ds_read_b64_tr_b16 v[140:141], v152 offset:12288
    ds_read_b64_tr_b16 v[142:143], v152 offset:13824
    s_waitcnt lgkmcnt(4)
    v_mfma_f32_16x16x32_bf16 a[4:7], v[132:135], v[16:19], a[4:7]
    v_mfma_f32_16x16x32_bf16 a[16:19], v[132:135], v[72:75], a[16:19]
    ds_read_b64_tr_b16 v[128:129], v153 offset:12288
    ds_read_b64_tr_b16 v[130:131], v153 offset:13824
    s_waitcnt lgkmcnt(4)
    v_mfma_f32_16x16x32_bf16 a[8:11], v[136:139], v[16:19], a[8:11]
    v_mfma_f32_16x16x32_bf16 a[20:23], v[136:139], v[72:75], a[20:23]
    ds_read_b64_tr_b16 v[132:133], v154 offset:12288
    ds_read_b64_tr_b16 v[134:135], v154 offset:13824
    s_waitcnt lgkmcnt(4)
    v_mfma_f32_16x16x32_bf16 a[0:3], v[140:143], v[20:23], a[0:3]
    v_mfma_f32_16x16x32_bf16 a[12:15], v[140:143], v[76:79], a[12:15]
    ds_read_b64_tr_b16 v[136:137], v152 offset:24576
    ds_read_b64_tr_b16 v[138:139], v152 offset:26112
    s_waitcnt lgkmcnt(4)
    v_mfma_f32_16x16x32_bf16 a[4:7], v[128:131], v[20:23], a[4:7]
    v_mfma_f32_16x16x32_bf16 a[16:19], v[128:131], v[76:79], a[16:19]
    ds_read_b64_tr_b16 v[140:141], v153 offset:24576
    ds_read_b64_tr_b16 v[142:143], v153 offset:26112
    s_waitcnt lgkmcnt(4)
    v_mfma_f32_16x16x32_bf16 a[8:11], v[132:135], v[20:23], a[8:11]
    v_mfma_f32_16x16x32_bf16 a[20:23], v[132:135], v[76:79], a[20:23]
    ds_read_b64_tr_b16 v[128:129], v154 offset:24576
    ds_read_b64_tr_b16 v[130:131], v154 offset:26112
    s_waitcnt lgkmcnt(4)
    v_mfma_f32_16x16x32_bf16 a[0:3], v[136:139], v[24:27], a[0:3]
    v_mfma_f32_16x16x32_bf16 a[12:15], v[136:139], v[80:83], a[12:15]
    ds_read_b64_tr_b16 v[132:133], v152 offset:36864
    ds_read_b64_tr_b16 v[134:135], v152 offset:38400
    s_waitcnt lgkmcnt(4)
    v_mfma_f32_16x16x32_bf16 a[4:7], v[140:143], v[24:27], a[4:7]
    v_mfma_f32_16x16x32_bf16 a[16:19], v[140:143], v[80:83], a[16:19]
    ds_read_b64_tr_b16 v[136:137], v153 offset:36864
    ds_read_b64_tr_b16 v[138:139], v153 offset:38400
    s_waitcnt lgkmcnt(4)
    v_mfma_f32_16x16x32_bf16 a[8:11], v[128:131], v[24:27], a[8:11]
    v_mfma_f32_16x16x32_bf16 a[20:23], v[128:131], v[80:83], a[20:23]
    ds_read_b64_tr_b16 v[140:141], v154 offset:36864
    ds_read_b64_tr_b16 v[142:143], v154 offset:38400
    s_waitcnt lgkmcnt(4)
    v_mfma_f32_16x16x32_bf16 a[0:3], v[132:135], v[28:31], a[0:3]
    v_mfma_f32_16x16x32_bf16 a[12:15], v[132:135], v[84:87], a[12:15]
    ds_read_b64_tr_b16 v[128:129], v152 offset:49152
    ds_read_b64_tr_b16 v[130:131], v152 offset:50688
    s_waitcnt lgkmcnt(4)
    v_mfma_f32_16x16x32_bf16 a[4:7], v[136:139], v[28:31], a[4:7]
    v_mfma_f32_16x16x32_bf16 a[16:19], v[136:139], v[84:87], a[16:19]
    ds_read_b64_tr_b16 v[132:133], v153 offset:49152
    ds_read_b64_tr_b16 v[134:135], v153 offset:50688
    s_waitcnt lgkmcnt(4)
    v_mfma_f32_16x16x32_bf16 a[8:11], v[140:143], v[28:31], a[8:11]
    v_mfma_f32_16x16x32_bf16 a[20:23], v[140:143], v[84:87], a[20:23]
    ds_read_b64_tr_b16 v[136:137], v154 offset:49152
    ds_read_b64_tr_b16 v[138:139], v154 offset:50688
    s_waitcnt lgkmcnt(4)
    v_mfma_f32_16x16x32_bf16 a[0:3], v[128:131], v[32:35], a[0:3]
    v_mfma_f32_16x16x32_bf16 a[12:15], v[128:131], v[88:91], a[12:15]
    ds_read_b64_tr_b16 v[140:141], v152 offset:61440
    ds_read_b64_tr_b16 v[142:143], v152 offset:62976
    s_waitcnt lgkmcnt(4)
    v_mfma_f32_16x16x32_bf16 a[4:7], v[132:135], v[32:35], a[4:7]
    v_mfma_f32_16x16x32_bf16 a[16:19], v[132:135], v[88:91], a[16:19]
    ds_read_b64_tr_b16 v[128:129], v153 offset:61440
    ds_read_b64_tr_b16 v[130:131], v153 offset:62976
    s_waitcnt lgkmcnt(4)
    v_mfma_f32_16x16x32_bf16 a[8:11], v[136:139], v[32:35], a[8:11]
    v_mfma_f32_16x16x32_bf16 a[20:23], v[136:139], v[88:91], a[20:23]
    ds_read_b64_tr_b16 v[132:133], v154 offset:61440
    ds_read_b64_tr_b16 v[134:135], v154 offset:62976
    s_waitcnt lgkmcnt(4)
    v_mfma_f32_16x16x32_bf16 a[0:3], v[140:143], v[36:39], a[0:3]
    v_mfma_f32_16x16x32_bf16 a[12:15], v[140:143], v[92:95], a[12:15]
    ds_read_b64_tr_b16 v[136:137], v155 offset:8192
    ds_read_b64_tr_b16 v[138:139], v155 offset:9728
    s_waitcnt lgkmcnt(4)
    v_mfma_f32_16x16x32_bf16 a[4:7], v[128:131], v[36:39], a[4:7]
    v_mfma_f32_16x16x32_bf16 a[16:19], v[128:131], v[92:95], a[16:19]
    ds_read_b64_tr_b16 v[140:141], v156 offset:8192
    ds_read_b64_tr_b16 v[142:143], v156 offset:9728
    s_waitcnt lgkmcnt(4)
    v_mfma_f32_16x16x32_bf16 a[8:11], v[132:135], v[36:39], a[8:11]
    v_mfma_f32_16x16x32_bf16 a[20:23], v[132:135], v[92:95], a[20:23]
    ds_read_b64_tr_b16 v[128:129], v157 offset:8192
    ds_read_b64_tr_b16 v[130:131], v157 offset:9728
    s_waitcnt lgkmcnt(4)
    v_mfma_f32_16x16x32_bf16 a[0:3], v[136:139], v[40:43], a[0:3]
    v_mfma_f32_16x16x32_bf16 a[12:15], v[136:139], v[96:99], a[12:15]
    ds_read_b64_tr_b16 v[132:133], v155 offset:20480
    ds_read_b64_tr_b16 v[134:135], v155 offset:22016
    s_waitcnt lgkmcnt(4)
    v_mfma_f32_16x16x32_bf16 a[4:7], v[140:143], v[40:43], a[4:7]
    v_mfma_f32_16x16x32_bf16 a[16:19], v[140:143], v[96:99], a[16:19]
    ds_read_b64_tr_b16 v[136:137], v156 offset:20480
    ds_read_b64_tr_b16 v[138:139], v156 offset:22016
    s_waitcnt lgkmcnt(4)
    v_mfma_f32_16x16x32_bf16 a[8:11], v[128:131], v[40:43], a[8:11]
    v_mfma_f32_16x16x32_bf16 a[20:23], v[128:131], v[96:99], a[20:23]
    ds_read_b64_tr_b16 v[140:141], v157 offset:20480
    ds_read_b64_tr_b16 v[142:143], v157 offset:22016
    s_waitcnt lgkmcnt(4)
    v_mfma_f32_16x16x32_bf16 a[0:3], v[132:135], v[44:47], a[0:3]
    v_mfma_f32_16x16x32_bf16 a[12:15], v[132:135], v[100:103], a[12:15]
    s_waitcnt lgkmcnt(2)
    v_mfma_f32_16x16x32_bf16 a[4:7], v[136:139], v[44:47], a[4:7]
    v_mfma_f32_16x16x32_bf16 a[16:19], v[136:139], v[100:103], a[16:19]
    s_waitcnt lgkmcnt(0)
    v_mfma_f32_16x16x32_bf16 a[8:11], v[140:143], v[44:47], a[8:11]
    v_mfma_f32_16x16x32_bf16 a[20:23], v[140:143], v[100:103], a[20:23]
    s_waitcnt vmcnt(0)
    s_barrier
    s_mov_b32 exec_hi, 0xffff
    s_add_u32 s30, s39, 65536
    s_mov_b32 m0, s30
    s_add_u32 s31, s38, 1118208
    buffer_load_dwordx4 v2, s[12:15], s31 offen lds
    s_add_u32 s30, s39, 66304
    s_mov_b32 m0, s30
    s_add_u32 s31, s38, 1123584
    buffer_load_dwordx4 v2, s[12:15], s31 offen lds
    s_mov_b32 exec_hi, -1
    ds_read_b64_tr_b16 v[128:129], v5 offset:0
    ds_read_b64_tr_b16 v[130:131], v5 offset:1536
    ds_read_b64_tr_b16 v[132:133], v6 offset:0
    ds_read_b64_tr_b16 v[134:135], v6 offset:1536
    ds_read_b64_tr_b16 v[136:137], v7 offset:0
    ds_read_b64_tr_b16 v[138:139], v7 offset:1536
    s_waitcnt lgkmcnt(4)
    v_mfma_f32_16x16x32_bf16 a[0:3], v[128:131], v[48:51], a[0:3]
    v_mfma_f32_16x16x32_bf16 a[12:15], v[128:131], v[104:107], a[12:15]
    ds_read_b64_tr_b16 v[140:141], v5 offset:12288
    ds_read_b64_tr_b16 v[142:143], v5 offset:13824
    s_waitcnt lgkmcnt(4)
    v_mfma_f32_16x16x32_bf16 a[4:7], v[132:135], v[48:51], a[4:7]
    v_mfma_f32_16x16x32_bf16 a[16:19], v[132:135], v[104:107], a[16:19]
    ds_read_b64_tr_b16 v[128:129], v6 offset:12288
    ds_read_b64_tr_b16 v[130:131], v6 offset:13824
    s_waitcnt lgkmcnt(4)
    v_mfma_f32_16x16x32_bf16 a[8:11], v[136:139], v[48:51], a[8:11]
    v_mfma_f32_16x16x32_bf16 a[20:23], v[136:139], v[104:107], a[20:23]
    ds_read_b64_tr_b16 v[132:133], v7 offset:12288
    ds_read_b64_tr_b16 v[134:135], v7 offset:13824
    s_waitcnt lgkmcnt(4)
    v_mfma_f32_16x16x32_bf16 a[0:3], v[140:143], v[52:55], a[0:3]
    v_mfma_f32_16x16x32_bf16 a[12:15], v[140:143], v[108:111], a[12:15]
    ds_read_b64_tr_b16 v[136:137], v5 offset:24576
    ds_read_b64_tr_b16 v[138:139], v5 offset:26112
    s_waitcnt lgkmcnt(4)
    v_mfma_f32_16x16x32_bf16 a[4:7], v[128:131], v[52:55], a[4:7]
    v_mfma_f32_16x16x32_bf16 a[16:19], v[128:131], v[108:111], a[16:19]
    ds_read_b64_tr_b16 v[140:141], v6 offset:24576
    ds_read_b64_tr_b16 v[142:143], v6 offset:26112
    s_waitcnt lgkmcnt(4)
    v_mfma_f32_16x16x32_bf16 a[8:11], v[132:135], v[52:55], a[8:11]
    v_mfma_f32_16x16x32_bf16 a[20:23], v[132:135], v[108:111], a[20:23]
    ds_read_b64_tr_b16 v[128:129], v7 offset:24576
    ds_read_b64_tr_b16 v[130:131], v7 offset:26112
    s_waitcnt lgkmcnt(4)
    v_mfma_f32_16x16x32_bf16 a[0:3], v[136:139], v[56:59], a[0:3]
    v_mfma_f32_16x16x32_bf16 a[12:15], v[136:139], v[112:115], a[12:15]
    ds_read_b64_tr_b16 v[132:133], v5 offset:36864
    ds_read_b64_tr_b16 v[134:135], v5 offset:38400
    s_waitcnt lgkmcnt(4)
    v_mfma_f32_16x16x32_bf16 a[4:7], v[140:143], v[56:59], a[4:7]
    v_mfma_f32_16x16x32_bf16 a[16:19], v[140:143], v[112:115], a[16:19]
    ds_read_b64_tr_b16 v[136:137], v6 offset:36864
    ds_read_b64_tr_b16 v[138:139], v6 offset:38400
    s_waitcnt lgkmcnt(4)
    v_mfma_f32_16x16x32_bf16 a[8:11], v[128:131], v[56:59], a[8:11]
    v_mfma_f32_16x16x32_bf16 a[20:23], v[128:131], v[112:115], a[20:23]
    ds_read_b64_tr_b16 v[140:141], v7 offset:36864
    ds_read_b64_tr_b16 v[142:143], v7 offset:38400
    s_waitcnt lgkmcnt(4)
    v_mfma_f32_16x16x32_bf16 a[0:3], v[132:135], v[60:63], a[0:3]
    v_mfma_f32_16x16x32_bf16 a[12:15], v[132:135], v[116:119], a[12:15]
    ds_read_b64_tr_b16 v[128:129], v5 offset:49152
    ds_read_b64_tr_b16 v[130:131], v5 offset:50688
    s_waitcnt lgkmcnt(4)
    v_mfma_f32_16x16x32_bf16 a[4:7], v[136:139], v[60:63], a[4:7]
    v_mfma_f32_16x16x32_bf16 a[16:19], v[136:139], v[116:119], a[16:19]
    ds_read_b64_tr_b16 v[132:133], v6 offset:49152
    ds_read_b64_tr_b16 v[134:135], v6 offset:50688
    s_waitcnt lgkmcnt(4)
    v_mfma_f32_16x16x32_bf16 a[8:11], v[140:143], v[60:63], a[8:11]
    v_mfma_f32_16x16x32_bf16 a[20:23], v[140:143], v[116:119], a[20:23]
    ds_read_b64_tr_b16 v[136:137], v7 offset:49152
    ds_read_b64_tr_b16 v[138:139], v7 offset:50688
    s_waitcnt lgkmcnt(4)
    v_mfma_f32_16x16x32_bf16 a[0:3], v[128:131], v[64:67], a[0:3]
    v_mfma_f32_16x16x32_bf16 a[12:15], v[128:131], v[120:123], a[12:15]
    s_waitcnt lgkmcnt(2)
    v_mfma_f32_16x16x32_bf16 a[4:7], v[132:135], v[64:67], a[4:7]
    v_mfma_f32_16x16x32_bf16 a[16:19], v[132:135], v[120:123], a[16:19]
    s_waitcnt lgkmcnt(0)
    v_mfma_f32_16x16x32_bf16 a[8:11], v[136:139], v[64:67], a[8:11]
    v_mfma_f32_16x16x32_bf16 a[20:23], v[136:139], v[120:123], a[20:23]
    s_waitcnt vmcnt(0)
    s_barrier
    ds_read_b64_tr_b16 v[140:141], v152 offset:0
    ds_read_b64_tr_b16 v[142:143], v152 offset:1536
    ds_read_b64_tr_b16 v[128:129], v153 offset:0
    ds_read_b64_tr_b16 v[130:131], v153 offset:1536
    ds_read_b64_tr_b16 v[132:133], v154 offset:0
    ds_read_b64_tr_b16 v[134:135], v154 offset:1536
    s_waitcnt lgkmcnt(4)
    v_mfma_f32_16x16x32_bf16 a[0:3], v[140:143], v[68:71], a[0:3]
    v_mfma_f32_16x16x32_bf16 a[12:15], v[140:143], v[124:127], a[12:15]
    s_waitcnt lgkmcnt(2)
    v_mfma_f32_16x16x32_bf16 a[4:7], v[128:131], v[68:71], a[4:7]
    v_mfma_f32_16x16x32_bf16 a[16:19], v[128:131], v[124:127], a[16:19]
    s_waitcnt lgkmcnt(0)
    v_mfma_f32_16x16x32_bf16 a[8:11], v[132:135], v[68:71], a[8:11]
    v_mfma_f32_16x16x32_bf16 a[20:23], v[132:135], v[124:127], a[20:23]
    s_nop 8
    v_and_b32 v3, 15, v1
    v_add_u32 v3, s28, v3
    v_mul_u32_u24 v3, 2688, v3
    v_lshrrev_b32 v4, 4, v1
    v_lshl_add_u32 v3, v4, 3, v3
    v_add_u32 v4, 43008, v3
    s_mul_i32 s30, s27, 384
    s_add_u32 s30, s30, s29
    v_accvgpr_read_b32 v8, a0
    v_accvgpr_read_b32 v9, a1
    v_accvgpr_read_b32 v10, a2
    v_accvgpr_read_b32 v11, a3
    v_cvt_pk_bf16_f32 v12, v8, v9
    v_cvt_pk_bf16_f32 v13, v10, v11
    buffer_store_dwordx2 v[12:13], v3, s[16:19], s30 offen offset:0
    s_nop 1
    v_accvgpr_read_b32 v8, a4
    v_accvgpr_read_b32 v9, a5
    v_accvgpr_read_b32 v10, a6
    v_accvgpr_read_b32 v11, a7
    v_cvt_pk_bf16_f32 v12, v8, v9
    v_cvt_pk_bf16_f32 v13, v10, v11
    buffer_store_dwordx2 v[12:13], v3, s[16:19], s30 offen offset:32
    s_nop 1
    v_accvgpr_read_b32 v8, a8
    v_accvgpr_read_b32 v9, a9
    v_accvgpr_read_b32 v10, a10
    v_accvgpr_read_b32 v11, a11
    v_cvt_pk_bf16_f32 v12, v8, v9
    v_cvt_pk_bf16_f32 v13, v10, v11
    buffer_store_dwordx2 v[12:13], v3, s[16:19], s30 offen offset:64
    s_nop 1
    v_accvgpr_read_b32 v8, a12
    v_accvgpr_read_b32 v9, a13
    v_accvgpr_read_b32 v10, a14
    v_accvgpr_read_b32 v11, a15
    v_cvt_pk_bf16_f32 v12, v8, v9
    v_cvt_pk_bf16_f32 v13, v10, v11
    buffer_store_dwordx2 v[12:13], v4, s[16:19], s30 offen offset:0
    s_nop 1
    v_accvgpr_read_b32 v8, a16
    v_accvgpr_read_b32 v9, a17
    v_accvgpr_read_b32 v10, a18
    v_accvgpr_read_b32 v11, a19
    v_cvt_pk_bf16_f32 v12, v8, v9
    v_cvt_pk_bf16_f32 v13, v10, v11
    buffer_store_dwordx2 v[12:13], v4, s[16:19], s30 offen offset:32
    s_nop 1
    v_accvgpr_read_b32 v8, a20
    v_accvgpr_read_b32 v9, a21
    v_accvgpr_read_b32 v10, a22
    v_accvgpr_read_b32 v11, a23
    v_cvt_pk_bf16_f32 v12, v8, v9
    v_cvt_pk_bf16_f32 v13, v10, v11
    buffer_store_dwordx2 v[12:13], v4, s[16:19], s30 offen offset:64
    s_nop 1
    s_waitcnt vmcnt(0)
k1_kernel_end:
    s_endpgm
.globl k2_kernel
.p2align 8
.type k2_kernel,@function
k2_kernel:
    s_load_dwordx2 s[4:5], s[0:1], 0
    s_load_dwordx2 s[6:7], s[0:1], 16
    s_load_dwordx2 s[20:21], s[0:1], 72
    s_cmp_ge_u32 s2, 256
    s_cbranch_scc1 k2_kernel_end
    v_lshrrev_b32 v2, 6, v0
    v_and_b32 v1, 63, v0
    s_nop 0
    v_readfirstlane_b32 s3, v2
    s_waitcnt lgkmcnt(0)
    s_mov_b32 s8, s4
    s_mov_b32 s9, s5
    s_mov_b32 s10, 0x1c0000
    s_mov_b32 s11, 0x00020000
    s_mov_b32 s12, s6
    s_mov_b32 s13, s7
    s_mov_b32 s14, 0x62000
    s_mov_b32 s15, 0x00020000
    s_mov_b32 s16, s20
    s_mov_b32 s17, s21
    s_mov_b32 s18, 0x540000
    s_mov_b32 s19, 0x00020000
    s_add_u32 s32, s20, 0x600000
    s_addc_u32 s33, s21, 0
    s_mov_b32 s34, 0x1c0000
    s_mov_b32 s35, 0x00020000
    s_and_b32 s24, s2, 7
    s_lshr_b32 s25, s2, 3
    s_and_b32 s27, s25, 1
    s_lshr_b32 s25, s25, 1
    s_lshl_b32 s24, s24, 4
    s_add_u32 s24, s24, s25
    s_lshl_b32 s28, s24, 4
    s_mul_i32 s29, s3, 17536
    s_mov_b32 s41, 2688
    v_lshrrev_b32 v2, 3, v1
    v_and_b32 v3, 7, v1
    s_sub_u32 s30, s28, 16
    v_add_u32 v4, s30, v2
    v_mul_lo_u32 v4, v4, s41
    v_lshl_add_u32 v4, v3, 4, v4
    s_mul_i32 s31, s3, 112
    s_add_u32 s31, s31, 1792
    v_add_u32 v4, s31, v4
    s_add_u32 s30, s29, 0
    s_mov_b32 m0, s30
    s_nop 0
    buffer_load_dwordx4 v4, s[16:19], 0 offen lds
    v_add_u32 v4, 21504, v4
    s_add_u32 s30, s29, 1024
    s_mov_b32 m0, s30
    s_nop 0
    buffer_load_dwordx4 v4, s[16:19], 0 offen lds
    v_add_u32 v4, 21504, v4
    s_add_u32 s30, s29, 2048
    s_mov_b32 m0, s30
    s_nop 0
    buffer_load_dwordx4 v4, s[16:19], 0 offen lds
    v_add_u32 v4, 21504, v4
    s_add_u32 s30, s29, 3072
    s_mov_b32 m0, s30
    s_nop 0
    buffer_load_dwordx4 v4, s[16:19], 0 offen lds
    v_add_u32 v4, 21504, v4
    v_mul_u32_u24 v2, 0x4925, v1
    v_lshrrev_b32 v2, 18, v2
    v_mul_u32_u24 v3, 14, v2
    v_sub_u32 v3, v1, v3
    s_mul_i32 s30, s3, 56
    v_add_u32 v5, s30, v2
    v_mul_u32_u24 v5, 896, v5
    v_lshl_add_u32 v5, v3, 4, v5
    s_mul_i32 s30, s27, 448
    v_add_u32 v5, s30, v5
    s_mov_b32 exec_hi, 0x00ffffff
    s_add_u32 s30, s29, 4096
    s_mov_b32 m0, s30
    s_mov_b32 s31, 0
    buffer_load_dwordx4 v5, s[12:15], s31 offen lds
    s_add_u32 s30, s29, 4992
    s_mov_b32 m0, s30
    s_mov_b32 s31, 3584
    buffer_load_dwordx4 v5, s[12:15], s31 offen lds
    s_add_u32 s30, s29, 5888
    s_mov_b32 m0, s30
    s_mov_b32 s31, 7168
    buffer_load_dwordx4 v5, s[12:15], s31 offen lds
    s_add_u32 s30, s29, 6784
    s_mov_b32 m0, s30
    s_mov_b32 s31, 10752
    buffer_load_dwordx4 v5, s[12:15], s31 offen lds
    s_add_u32 s30, s29, 7680
    s_mov_b32 m0, s30
    s_mov_b32 s31, 14336
    buffer_load_dwordx4 v5, s[12:15], s31 offen lds
    s_add_u32 s30, s29, 8576
    s_mov_b32 m0, s30
    s_mov_b32 s31, 17920
    buffer_load_dwordx4 v5, s[12:15], s31 offen lds
    s_add_u32 s30, s29, 9472
    s_mov_b32 m0, s30
    s_mov_b32 s31, 21504
    buffer_load_dwordx4 v5, s[12:15], s31 offen lds
    s_add_u32 s30, s29, 10368
    s_mov_b32 m0, s30
    s_mov_b32 s31, 25088
    buffer_load_dwordx4 v5, s[12:15], s31 offen lds
    s_add_u32 s30, s29, 11264
    s_mov_b32 m0, s30
    s_mov_b32 s31, 28672
    buffer_load_dwordx4 v5, s[12:15], s31 offen lds
    s_add_u32 s30, s29, 12160
    s_mov_b32 m0, s30
    s_mov_b32 s31, 32256
    buffer_load_dwordx4 v5, s[12:15], s31 offen lds
    s_add_u32 s30, s29, 13056
    s_mov_b32 m0, s30
    s_mov_b32 s31, 35840
    buffer_load_dwordx4 v5, s[12:15], s31 offen lds
    s_add_u32 s30, s29, 13952
    s_mov_b32 m0, s30
    s_mov_b32 s31, 39424
    buffer_load_dwordx4 v5, s[12:15], s31 offen lds
    s_add_u32 s30, s29, 14848
    s_mov_b32 m0, s30
    s_mov_b32 s31, 43008
    buffer_load_dwordx4 v5, s[12:15], s31 offen lds
    s_add_u32 s30, s29, 15744
    s_mov_b32 m0, s30
    s_mov_b32 s31, 46592
    buffer_load_dwordx4 v5, s[12:15], s31 offen lds
    s_add_u32 s30, s29, 16640
    s_mov_b32 m0, s30
    s_mov_b32 s31, 50176
    buffer_load_dwordx4 v5, s[12:15], s31 offen lds
    s_mov_b32 exec_hi, -1
    v_and_b32 v7, 15, v1
    v_lshrrev_b32 v8, 4, v1
    v_add_u32 v6, s28, v7
    v_mul_lo_u32 v6, v6, s41
    v_lshl_add_u32 v6, v8, 4, v6
    s_mul_i32 s30, s3, 112
    v_add_u32 v6, s30, v6
    v_add_u32 v9, 4294925184, v6
    buffer_load_dwordx4 v[64:67], v6, s[16:19], 0 offen offset:0
    buffer_load_dwordx4 v[68:71], v6, s[16:19], 0 offen offset:56
    buffer_load_dwordx4 v[72:75], v9, s[16:19], 0 offen offset:0
    buffer_load_dwordx4 v[80:83], v9, s[16:19], 0 offen offset:56
    v_add_u32 v9, 43008, v9
    buffer_load_dwordx4 v[76:79], v9, s[16:19], 0 offen offset:0
    buffer_load_dwordx4 v[84:87], v9, s[16:19], 0 offen offset:56
    v_lshlrev_b32 v10, 2, v8
    v_add_u32 v10, 0, v10
    v_sub_u32 v11, v7, v10
    v_add_u32 v11, 16, v11
    v_add_u32 v12, s28, v10
    v_mov_b32 v16, 0xf149f2ca
    v_cmp_gt_u32 vcc, 15, v11
    s_nop 1
    v_cndmask_b32 v13, v16, 0, vcc
    v_mov_b32 v14, v16
    v_and_b32 v11, 1, v11
    v_cmp_eq_u32 vcc, 0, v11
    s_nop 1
    v_cndmask_b32 v13, v14, v13, vcc
    v_cmp_le_u32 vcc, 16, v12
    s_nop 1
    v_cndmask_b32 v16, v14, v13, vcc
    v_lshlrev_b32 v10, 2, v8
    v_add_u32 v10, 1, v10
    v_sub_u32 v11, v7, v10
    v_add_u32 v11, 16, v11
    v_add_u32 v12, s28, v10
    v_mov_b32 v17, 0xf149f2ca
    v_cmp_gt_u32 vcc, 15, v11
    s_nop 1
    v_cndmask_b32 v13, v17, 0, vcc
    v_mov_b32 v14, v17
    v_and_b32 v11, 1, v11
    v_cmp_eq_u32 vcc, 0, v11
    s_nop 1
    v_cndmask_b32 v13, v14, v13, vcc
    v_cmp_le_u32 vcc, 16, v12
    s_nop 1
    v_cndmask_b32 v17, v14, v13, vcc
    v_lshlrev_b32 v10, 2, v8
    v_add_u32 v10, 2, v10
    v_sub_u32 v11, v7, v10
    v_add_u32 v11, 16, v11
    v_add_u32 v12, s28, v10
    v_mov_b32 v18, 0xf149f2ca
    v_cmp_gt_u32 vcc, 15, v11
    s_nop 1
    v_cndmask_b32 v13, v18, 0, vcc
    v_mov_b32 v14, v18
    v_and_b32 v11, 1, v11
    v_cmp_eq_u32 vcc, 0, v11
    s_nop 1
    v_cndmask_b32 v13, v14, v13, vcc
    v_cmp_le_u32 vcc, 16, v12
    s_nop 1
    v_cndmask_b32 v18, v14, v13, vcc
    v_lshlrev_b32 v10, 2, v8
    v_add_u32 v10, 3, v10
    v_sub_u32 v11, v7, v10
    v_add_u32 v11, 16, v11
    v_add_u32 v12, s28, v10
    v_mov_b32 v19, 0xf149f2ca
    v_cmp_gt_u32 vcc, 15, v11
    s_nop 1
    v_cndmask_b32 v13, v19, 0, vcc
    v_mov_b32 v14, v19
    v_and_b32 v11, 1, v11
    v_cmp_eq_u32 vcc, 0, v11
    s_nop 1
    v_cndmask_b32 v13, v14, v13, vcc
    v_cmp_le_u32 vcc, 16, v12
    s_nop 1
    v_cndmask_b32 v19, v14, v13, vcc
    v_lshlrev_b32 v10, 2, v8
    v_add_u32 v10, 16, v10
    v_sub_u32 v11, v7, v10
    v_add_u32 v11, 16, v11
    v_add_u32 v12, s28, v10
    v_mov_b32 v20, 0xf149f2ca
    v_cmp_gt_u32 vcc, 15, v11
    s_nop 1
    v_cndmask_b32 v13, v20, 0, vcc
    v_mov_b32 v14, v20
    v_and_b32 v11, 1, v11
    v_cmp_eq_u32 vcc, 0, v11
    s_nop 1
    v_cndmask_b32 v13, v14, v13, vcc
    v_cmp_le_u32 vcc, 16, v12
    s_nop 1
    v_cndmask_b32 v20, v14, v13, vcc
    v_lshlrev_b32 v10, 2, v8
    v_add_u32 v10, 17, v10
    v_sub_u32 v11, v7, v10
    v_add_u32 v11, 16, v11
    v_add_u32 v12, s28, v10
    v_mov_b32 v21, 0xf149f2ca
    v_cmp_gt_u32 vcc, 15, v11
    s_nop 1
    v_cndmask_b32 v13, v21, 0, vcc
    v_mov_b32 v14, v21
    v_and_b32 v11, 1, v11
    v_cmp_eq_u32 vcc, 0, v11
    s_nop 1
    v_cndmask_b32 v13, v14, v13, vcc
    v_cmp_le_u32 vcc, 16, v12
    s_nop 1
    v_cndmask_b32 v21, v14, v13, vcc
    v_lshlrev_b32 v10, 2, v8
    v_add_u32 v10, 18, v10
    v_sub_u32 v11, v7, v10
    v_add_u32 v11, 16, v11
    v_add_u32 v12, s28, v10
    v_mov_b32 v22, 0xf149f2ca
    v_cmp_gt_u32 vcc, 15, v11
    s_nop 1
    v_cndmask_b32 v13, v22, 0, vcc
    v_mov_b32 v14, v22
    v_and_b32 v11, 1, v11
    v_cmp_eq_u32 vcc, 0, v11
    s_nop 1
    v_cndmask_b32 v13, v14, v13, vcc
    v_cmp_le_u32 vcc, 16, v12
    s_nop 1
    v_cndmask_b32 v22, v14, v13, vcc
    v_lshlrev_b32 v10, 2, v8
    v_add_u32 v10, 19, v10
    v_sub_u32 v11, v7, v10
    v_add_u32 v11, 16, v11
    v_add_u32 v12, s28, v10
    v_mov_b32 v23, 0xf149f2ca
    v_cmp_gt_u32 vcc, 15, v11
    s_nop 1
    v_cndmask_b32 v13, v23, 0, vcc
    v_mov_b32 v14, v23
    v_and_b32 v11, 1, v11
    v_cmp_eq_u32 vcc, 0, v11
    s_nop 1
    v_cndmask_b32 v13, v14, v13, vcc
    v_cmp_le_u32 vcc, 16, v12
    s_nop 1
    v_cndmask_b32 v23, v14, v13, vcc
    v_bfe_u32 v10, v1, 2, 4
    v_and_b32 v11, 3, v1
    v_lshlrev_b32 v11, 3, v11
    v_mul_u32_u24 v15, 224, v10
    v_add3_u32 v15, v15, v11, s29
    v_add_u32 v15, 4096, v15
    v_lshl_add_u32 v10, v10, 7, v11
    v_add_u32 v10, s29, v10
    v_cmp_gt_u32 s[42:43], 48, v1
    v_accvgpr_write_b32 a0, 0
    v_accvgpr_write_b32 a1, 0
    v_accvgpr_write_b32 a2, 0
    v_accvgpr_write_b32 a3, 0
    v_accvgpr_write_b32 a4, 0
    v_accvgpr_write_b32 a5, 0
    v_accvgpr_write_b32 a6, 0
    v_accvgpr_write_b32 a7, 0
    v_accvgpr_write_b32 a8, 0
    v_accvgpr_write_b32 a9, 0
    v_accvgpr_write_b32 a10, 0
    v_accvgpr_write_b32 a11, 0
    v_accvgpr_write_b32 a12, 0
    v_accvgpr_write_b32 a13, 0
    v_accvgpr_write_b32 a14, 0
    v_accvgpr_write_b32 a15, 0
    v_accvgpr_write_b32 a16, 0
    v_accvgpr_write_b32 a17, 0
    v_accvgpr_write_b32 a18, 0
    v_accvgpr_write_b32 a19, 0
    v_accvgpr_write_b32 a20, 0
    v_accvgpr_write_b32 a21, 0
    v_accvgpr_write_b32 a22, 0
    v_accvgpr_write_b32 a23, 0
    v_accvgpr_write_b32 a24, 0
    v_accvgpr_write_b32 a25, 0
    v_accvgpr_write_b32 a26, 0
    v_accvgpr_write_b32 a27, 0
    v_accvgpr_write_b32 a28, 0
    v_accvgpr_write_b32 a29, 0
    v_accvgpr_write_b32 a30, 0
    v_accvgpr_write_b32 a31, 0
    v_accvgpr_write_b32 a32, 0
    v_accvgpr_write_b32 a33, 0
    v_accvgpr_write_b32 a34, 0
    v_accvgpr_write_b32 a35, 0
    v_accvgpr_write_b32 a36, 0
    v_accvgpr_write_b32 a37, 0
    v_accvgpr_write_b32 a38, 0
    v_accvgpr_write_b32 a39, 0
    v_accvgpr_write_b32 a40, 0
    v_accvgpr_write_b32 a41, 0
    v_accvgpr_write_b32 a42, 0
    v_accvgpr_write_b32 a43, 0
    v_accvgpr_write_b32 a44, 0
    v_accvgpr_write_b32 a45, 0
    v_accvgpr_write_b32 a46, 0
    v_accvgpr_write_b32 a47, 0
    v_accvgpr_write_b32 a48, 0
    v_accvgpr_write_b32 a49, 0
    v_accvgpr_write_b32 a50, 0
    v_accvgpr_write_b32 a51, 0
    v_accvgpr_write_b32 a52, 0
    v_accvgpr_write_b32 a53, 0
    v_accvgpr_write_b32 a54, 0
    v_accvgpr_write_b32 a55, 0
    s_waitcnt vmcnt(0)
    v_cndmask_b32 v66, 0, v66, s[42:43]
    v_cndmask_b32 v67, 0, v67, s[42:43]
    v_cndmask_b32 v70, 0, v70, s[42:43]
    v_cndmask_b32 v71, 0, v71, s[42:43]
    s_nop 1
    v_mfma_f32_16x16x32_bf16 v[24:27], v[72:75], v[64:67], 0
    v_mfma_f32_16x16x32_bf16 v[28:31], v[76:79], v[64:67], 0
    ds_read_b64_tr_b16 v[40:41], v10 offset:0
    ds_read_b64_tr_b16 v[42:43], v10 offset:2048
    ds_read_b64_tr_b16 v[44:45], v10 offset:32
    ds_read_b64_tr_b16 v[46:47], v10 offset:2080
    s_nop 7
    s_mov_b32 s44, 0x3e8b97f6
    v_fma_f32 v24, v24, s44, v16
    v_fma_f32 v25, v25, s44, v17
    v_fma_f32 v26, v26, s44, v18
    v_fma_f32 v27, v27, s44, v19
    v_fma_f32 v28, v28, s44, v20
    v_fma_f32 v29, v29, s44, v21
    v_fma_f32 v30, v30, s44, v22
    v_fma_f32 v31, v31, s44, v23
    v_max3_f32 v32, v24, v25, v26
    v_max3_f32 v33, v27, v28, v29
    v_max3_f32 v32, v32, v30, v31
    v_max_f32 v32, v32, v33
    ds_swizzle_b32 v33, v32 offset:0x401F
    s_waitcnt lgkmcnt(0)
    v_max_f32 v32, v32, v33
    v_mov_b32 v33, v32
    s_nop 1
    v_permlane32_swap_b32 v32, v33
    s_nop 1
    v_max_f32 v32, v32, v33
    v_sub_f32 v24, v24, v32
    v_sub_f32 v25, v25, v32
    v_sub_f32 v26, v26, v32
    v_sub_f32 v27, v27, v32
    v_sub_f32 v28, v28, v32
    v_sub_f32 v29, v29, v32
    v_sub_f32 v30, v30, v32
    v_sub_f32 v31, v31, v32
    v_exp_f32 v24, v24
    v_exp_f32 v25, v25
    v_exp_f32 v26, v26
    v_exp_f32 v27, v27
    v_exp_f32 v28, v28
    v_exp_f32 v29, v29
    v_exp_f32 v30, v30
    v_exp_f32 v31, v31
    s_nop 0
    v_add_f32 v32, v24, v25
    v_add_f32 v32, v32, v26
    v_add_f32 v32, v32, v27
    v_add_f32 v32, v32, v28
    v_add_f32 v32, v32, v29
    v_add_f32 v32, v32, v30
    v_add_f32 v32, v32, v31
    ds_swizzle_b32 v33, v32 offset:0x401F
    s_waitcnt lgkmcnt(0)
    v_add_f32 v32, v32, v33
    v_mov_b32 v33, v32
    s_nop 1
    v_permlane32_swap_b32 v32, v33
    s_nop 1
    v_add_f32 v32, v32, v33
    v_rcp_f32 v32, v32
    s_nop 0
    v_mul_f32 v24, v24, v32
    v_mul_f32 v25, v25, v32
    v_mul_f32 v26, v26, v32
    v_mul_f32 v27, v27, v32
    v_mul_f32 v28, v28, v32
    v_mul_f32 v29, v29, v32
    v_mul_f32 v30, v30, v32
    v_mul_f32 v31, v31, v32
    v_cvt_pk_bf16_f32 v36, v24, v25
    v_cvt_pk_bf16_f32 v37, v26, v27
    v_cvt_pk_bf16_f32 v38, v28, v29
    v_cvt_pk_bf16_f32 v39, v30, v31
    s_nop 1
    v_mfma_f32_16x16x32_bf16 v[24:27], v[40:43], v[36:39], 0
    v_mfma_f32_16x16x32_bf16 v[28:31], v[44:47], v[36:39], 0
    s_nop 8
    v_cndmask_b32 v28, 0, v28, s[42:43]
    v_cndmask_b32 v29, 0, v29, s[42:43]
    v_cndmask_b32 v30, 0, v30, s[42:43]
    v_cndmask_b32 v31, 0, v31, s[42:43]
    v_cvt_pk_bf16_f32 v96, v24, v25
    v_cvt_pk_bf16_f32 v97, v26, v27
    v_cvt_pk_bf16_f32 v98, v28, v29
    v_cvt_pk_bf16_f32 v99, v30, v31
    v_mfma_f32_16x16x32_bf16 v[24:27], v[80:83], v[68:71], 0
    v_mfma_f32_16x16x32_bf16 v[28:31], v[84:87], v[68:71], 0
    ds_read_b64_tr_b16 v[40:41], v10 offset:56
    ds_read_b64_tr_b16 v[42:43], v10 offset:2104
    ds_read_b64_tr_b16 v[44:45], v10 offset:88
    ds_read_b64_tr_b16 v[46:47], v10 offset:2136
    s_nop 7
    s_mov_b32 s44, 0x3e8b97f6
    v_fma_f32 v24, v24, s44, v16
    v_fma_f32 v25, v25, s44, v17
    v_fma_f32 v26, v26, s44, v18
    v_fma_f32 v27, v27, s44, v19
    v_fma_f32 v28, v28, s44, v20
    v_fma_f32 v29, v29, s44, v21
    v_fma_f32 v30, v30, s44, v22
    v_fma_f32 v31, v31, s44, v23
    v_max3_f32 v32, v24, v25, v26
    v_max3_f32 v33, v27, v28, v29
    v_max3_f32 v32, v32, v30, v31
    v_max_f32 v32, v32, v33
    ds_swizzle_b32 v33, v32 offset:0x401F
    s_waitcnt lgkmcnt(0)
    v_max_f32 v32, v32, v33
    v_mov_b32 v33, v32
    s_nop 1
    v_permlane32_swap_b32 v32, v33
    s_nop 1
    v_max_f32 v32, v32, v33
    v_sub_f32 v24, v24, v32
    v_sub_f32 v25, v25, v32
    v_sub_f32 v26, v26, v32
    v_sub_f32 v27, v27, v32
    v_sub_f32 v28, v28, v32
    v_sub_f32 v29, v29, v32
    v_sub_f32 v30, v30, v32
    v_sub_f32 v31, v31, v32
    v_exp_f32 v24, v24
    v_exp_f32 v25, v25
    v_exp_f32 v26, v26
    v_exp_f32 v27, v27
    v_exp_f32 v28, v28
    v_exp_f32 v29, v29
    v_exp_f32 v30, v30
    v_exp_f32 v31, v31
    s_nop 0
    v_add_f32 v32, v24, v25
    v_add_f32 v32, v32, v26
    v_add_f32 v32, v32, v27
    v_add_f32 v32, v32, v28
    v_add_f32 v32, v32, v29
    v_add_f32 v32, v32, v30
    v_add_f32 v32, v32, v31
    ds_swizzle_b32 v33, v32 offset:0x401F
    s_waitcnt lgkmcnt(0)
    v_add_f32 v32, v32, v33
    v_mov_b32 v33, v32
    s_nop 1
    v_permlane32_swap_b32 v32, v33
    s_nop 1
    v_add_f32 v32, v32, v33
    v_rcp_f32 v32, v32
    s_nop 0
    v_mul_f32 v24, v24, v32
    v_mul_f32 v25, v25, v32
    v_mul_f32 v26, v26, v32
    v_mul_f32 v27, v27, v32
    v_mul_f32 v28, v28, v32
    v_mul_f32 v29, v29, v32
    v_mul_f32 v30, v30, v32
    v_mul_f32 v31, v31, v32
    v_cvt_pk_bf16_f32 v36, v24, v25
    v_cvt_pk_bf16_f32 v37, v26, v27
    v_cvt_pk_bf16_f32 v38, v28, v29
    v_cvt_pk_bf16_f32 v39, v30, v31
    s_nop 1
    v_mfma_f32_16x16x32_bf16 v[24:27], v[40:43], v[36:39], 0
    v_mfma_f32_16x16x32_bf16 v[28:31], v[44:47], v[36:39], 0
    s_nop 8
    v_cndmask_b32 v28, 0, v28, s[42:43]
    v_cndmask_b32 v29, 0, v29, s[42:43]
    v_cndmask_b32 v30, 0, v30, s[42:43]
    v_cndmask_b32 v31, 0, v31, s[42:43]
    v_cvt_pk_bf16_f32 v100, v24, v25
    v_cvt_pk_bf16_f32 v101, v26, v27
    v_cvt_pk_bf16_f32 v102, v28, v29
    v_cvt_pk_bf16_f32 v103, v30, v31
    s_nop 1
    ds_read_b64_tr_b16 v[40:41], v15 offset:0
    ds_read_b64_tr_b16 v[42:43], v15 offset:3584
    ds_read_b64_tr_b16 v[44:45], v15 offset:32
    ds_read_b64_tr_b16 v[46:47], v15 offset:3616
    ds_read_b64_tr_b16 v[48:49], v15 offset:64
    ds_read_b64_tr_b16 v[50:51], v15 offset:3648
    s_waitcnt lgkmcnt(4)
    v_mfma_f32_16x16x32_bf16 a[0:3], v[40:43], v[96:99], a[0:3]
    ds_read_b64_tr_b16 v[52:53], v15 offset:96
    ds_read_b64_tr_b16 v[54:55], v15 offset:3680
    s_waitcnt lgkmcnt(4)
    v_mfma_f32_16x16x32_bf16 a[4:7], v[44:47], v[96:99], a[4:7]
    ds_read_b64_tr_b16 v[40:41], v15 offset:128
    ds_read_b64_tr_b16 v[42:43], v15 offset:3712
    s_waitcnt lgkmcnt(4)
    v_mfma_f32_16x16x32_bf16 a[8:11], v[48:51], v[96:99], a[8:11]
    ds_read_b64_tr_b16 v[44:45], v15 offset:160
    ds_read_b64_tr_b16 v[46:47], v15 offset:3744
    s_waitcnt lgkmcnt(4)
    v_mfma_f32_16x16x32_bf16 a[12:15], v[52:55], v[96:99], a[12:15]
    ds_read_b64_tr_b16 v[48:49], v15 offset:192
    ds_read_b64_tr_b16 v[50:51], v15 offset:3776
    s_waitcnt lgkmcnt(4)
    v_mfma_f32_16x16x32_bf16 a[16:19], v[40:43], v[96:99], a[16:19]
    ds_read_b64_tr_b16 v[52:53], v15 offset:6272
    ds_read_b64_tr_b16 v[54:55], v15 offset:9856
    s_waitcnt lgkmcnt(4)
    v_mfma_f32_16x16x32_bf16 a[20:23], v[44:47], v[96:99], a[20:23]
    ds_read_b64_tr_b16 v[40:41], v15 offset:6304
    ds_read_b64_tr_b16 v[42:43], v15 offset:9888
    s_waitcnt lgkmcnt(4)
    v_mfma_f32_16x16x32_bf16 a[24:27], v[48:51], v[96:99], a[24:27]
    ds_read_b64_tr_b16 v[44:45], v15 offset:6336
    ds_read_b64_tr_b16 v[46:47], v15 offset:9920
    s_waitcnt lgkmcnt(4)
    v_mfma_f32_16x16x32_bf16 a[0:3], v[52:55], v[100:103], a[0:3]
    ds_read_b64_tr_b16 v[48:49], v15 offset:6368
    ds_read_b64_tr_b16 v[50:51], v15 offset:9952
    s_waitcnt lgkmcnt(4)
    v_mfma_f32_16x16x32_bf16 a[4:7], v[40:43], v[100:103], a[4:7]
    ds_read_b64_tr_b16 v[52:53], v15 offset:6400
    ds_read_b64_tr_b16 v[54:55], v15 offset:9984
    s_waitcnt lgkmcnt(4)
    v_mfma_f32_16x16x32_bf16 a[8:11], v[44:47], v[100:103], a[8:11]
    ds_read_b64_tr_b16 v[40:41], v15 offset:6432
    ds_read_b64_tr_b16 v[42:43], v15 offset:10016
    s_waitcnt lgkmcnt(4)
    v_mfma_f32_16x16x32_bf16 a[12:15], v[48:51], v[100:103], a[12:15]
    ds_read_b64_tr_b16 v[44:45], v15 offset:6464
    ds_read_b64_tr_b16 v[46:47], v15 offset:10048
    s_waitcnt lgkmcnt(4)
    v_mfma_f32_16x16x32_bf16 a[16:19], v[52:55], v[100:103], a[16:19]
    s_waitcnt lgkmcnt(2)
    v_mfma_f32_16x16x32_bf16 a[20:23], v[40:43], v[100:103], a[20:23]
    s_waitcnt lgkmcnt(0)
    v_mfma_f32_16x16x32_bf16 a[24:27], v[44:47], v[100:103], a[24:27]
    s_waitcnt lgkmcnt(0)
    s_mov_b32 exec_hi, 0x00ffffff
    s_add_u32 s30, s29, 4096
    s_mov_b32 m0, s30
    s_mov_b32 s31, 224
    buffer_load_dwordx4 v5, s[12:15], s31 offen lds
    s_add_u32 s30, s29, 4992
    s_mov_b32 m0, s30
    s_mov_b32 s31, 3808
    buffer_load_dwordx4 v5, s[12:15], s31 offen lds
    s_add_u32 s30, s29, 5888
    s_mov_b32 m0, s30
    s_mov_b32 s31, 7392
    buffer_load_dwordx4 v5, s[12:15], s31 offen lds
    s_add_u32 s30, s29, 6784
    s_mov_b32 m0, s30
    s_mov_b32 s31, 10976
    buffer_load_dwordx4 v5, s[12:15], s31 offen lds
    s_add_u32 s30, s29, 7680
    s_mov_b32 m0, s30
    s_mov_b32 s31, 14560
    buffer_load_dwordx4 v5, s[12:15], s31 offen lds
    s_add_u32 s30, s29, 8576
    s_mov_b32 m0, s30
    s_mov_b32 s31, 18144
    buffer_load_dwordx4 v5, s[12:15], s31 offen lds
    s_add_u32 s30, s29, 9472
    s_mov_b32 m0, s30
    s_mov_b32 s31, 21728
    buffer_load_dwordx4 v5, s[12:15], s31 offen lds
    s_add_u32 s30, s29, 10368
    s_mov_b32 m0, s30
    s_mov_b32 s31, 25312
    buffer_load_dwordx4 v5, s[12:15], s31 offen lds
    s_add_u32 s30, s29, 11264
    s_mov_b32 m0, s30
    s_mov_b32 s31, 28896
    buffer_load_dwordx4 v5, s[12:15], s31 offen lds
    s_add_u32 s30, s29, 12160
    s_mov_b32 m0, s30
    s_mov_b32 s31, 32480
    buffer_load_dwordx4 v5, s[12:15], s31 offen lds
    s_add_u32 s30, s29, 13056
    s_mov_b32 m0, s30
    s_mov_b32 s31, 36064
    buffer_load_dwordx4 v5, s[12:15], s31 offen lds
    s_add_u32 s30, s29, 13952
    s_mov_b32 m0, s30
    s_mov_b32 s31, 39648
    buffer_load_dwordx4 v5, s[12:15], s31 offen lds
    s_add_u32 s30, s29, 14848
    s_mov_b32 m0, s30
    s_mov_b32 s31, 43232
    buffer_load_dwordx4 v5, s[12:15], s31 offen lds
    s_add_u32 s30, s29, 15744
    s_mov_b32 m0, s30
    s_mov_b32 s31, 46816
    buffer_load_dwordx4 v5, s[12:15], s31 offen lds
    s_add_u32 s30, s29, 16640
    s_mov_b32 m0, s30
    s_mov_b32 s31, 50400
    buffer_load_dwordx4 v5, s[12:15], s31 offen lds
    s_mov_b32 exec_hi, -1
    s_waitcnt vmcnt(0)
    ds_read_b64_tr_b16 v[40:41], v15 offset:0
    ds_read_b64_tr_b16 v[42:43], v15 offset:3584
    ds_read_b64_tr_b16 v[44:45], v15 offset:32
    ds_read_b64_tr_b16 v[46:47], v15 offset:3616
    ds_read_b64_tr_b16 v[48:49], v15 offset:64
    ds_read_b64_tr_b16 v[50:51], v15 offset:3648
    s_waitcnt lgkmcnt(4)
    v_mfma_f32_16x16x32_bf16 a[28:31], v[40:43], v[96:99], a[28:31]
    ds_read_b64_tr_b16 v[52:53], v15 offset:96
    ds_read_b64_tr_b16 v[54:55], v15 offset:3680
    s_waitcnt lgkmcnt(4)
    v_mfma_f32_16x16x32_bf16 a[32:35], v[44:47], v[96:99], a[32:35]
    ds_read_b64_tr_b16 v[40:41], v15 offset:128
    ds_read_b64_tr_b16 v[42:43], v15 offset:3712
    s_waitcnt lgkmcnt(4)
    v_mfma_f32_16x16x32_bf16 a[36:39], v[48:51], v[96:99], a[36:39]
    ds_read_b64_tr_b16 v[44:45], v15 offset:160
    ds_read_b64_tr_b16 v[46:47], v15 offset:3744
    s_waitcnt lgkmcnt(4)
    v_mfma_f32_16x16x32_bf16 a[40:43], v[52:55], v[96:99], a[40:43]
    ds_read_b64_tr_b16 v[48:49], v15 offset:192
    ds_read_b64_tr_b16 v[50:51], v15 offset:3776
    s_waitcnt lgkmcnt(4)
    v_mfma_f32_16x16x32_bf16 a[44:47], v[40:43], v[96:99], a[44:47]
    ds_read_b64_tr_b16 v[52:53], v15 offset:6272
    ds_read_b64_tr_b16 v[54:55], v15 offset:9856
    s_waitcnt lgkmcnt(4)
    v_mfma_f32_16x16x32_bf16 a[48:51], v[44:47], v[96:99], a[48:51]
    ds_read_b64_tr_b16 v[40:41], v15 offset:6304
    ds_read_b64_tr_b16 v[42:43], v15 offset:9888
    s_waitcnt lgkmcnt(4)
    v_mfma_f32_16x16x32_bf16 a[52:55], v[48:51], v[96:99], a[52:55]
    ds_read_b64_tr_b16 v[44:45], v15 offset:6336
    ds_read_b64_tr_b16 v[46:47], v15 offset:9920
    s_waitcnt lgkmcnt(4)
    v_mfma_f32_16x16x32_bf16 a[28:31], v[52:55], v[100:103], a[28:31]
    ds_read_b64_tr_b16 v[48:49], v15 offset:6368
    ds_read_b64_tr_b16 v[50:51], v15 offset:9952
    s_waitcnt lgkmcnt(4)
    v_mfma_f32_16x16x32_bf16 a[32:35], v[40:43], v[100:103], a[32:35]
    ds_read_b64_tr_b16 v[52:53], v15 offset:6400
    ds_read_b64_tr_b16 v[54:55], v15 offset:9984
    s_waitcnt lgkmcnt(4)
    v_mfma_f32_16x16x32_bf16 a[36:39], v[44:47], v[100:103], a[36:39]
    ds_read_b64_tr_b16 v[40:41], v15 offset:6432
    ds_read_b64_tr_b16 v[42:43], v15 offset:10016
    s_waitcnt lgkmcnt(4)
    v_mfma_f32_16x16x32_bf16 a[40:43], v[48:51], v[100:103], a[40:43]
    ds_read_b64_tr_b16 v[44:45], v15 offset:6464
    ds_read_b64_tr_b16 v[46:47], v15 offset:10048
    s_waitcnt lgkmcnt(4)
    v_mfma_f32_16x16x32_bf16 a[44:47], v[52:55], v[100:103], a[44:47]
    s_waitcnt lgkmcnt(2)
    v_mfma_f32_16x16x32_bf16 a[48:51], v[40:43], v[100:103], a[48:51]
    s_waitcnt lgkmcnt(0)
    v_mfma_f32_16x16x32_bf16 a[52:55], v[44:47], v[100:103], a[52:55]
    s_nop 8
    s_barrier
    v_lshlrev_b32 v10, 2, v1
    s_mul_i32 s30, s3, 14336
    v_add_u32 v11, s30, v10
    v_accvgpr_read_b32 v12, a0
    ds_write_b32 v11, v12 offset:0
    v_accvgpr_read_b32 v12, a1
    ds_write_b32 v11, v12 offset:256
    v_accvgpr_read_b32 v12, a2
    ds_write_b32 v11, v12 offset:512
    v_accvgpr_read_b32 v12, a3
    ds_write_b32 v11, v12 offset:768
    v_accvgpr_read_b32 v12, a4
    ds_write_b32 v11, v12 offset:1024
    v_accvgpr_read_b32 v12, a5
    ds_write_b32 v11, v12 offset:1280
    v_accvgpr_read_b32 v12, a6
    ds_write_b32 v11, v12 offset:1536
    v_accvgpr_read_b32 v12, a7
    ds_write_b32 v11, v12 offset:1792
    v_accvgpr_read_b32 v12, a8
    ds_write_b32 v11, v12 offset:2048
    v_accvgpr_read_b32 v12, a9
    ds_write_b32 v11, v12 offset:2304
    v_accvgpr_read_b32 v12, a10
    ds_write_b32 v11, v12 offset:2560
    v_accvgpr_read_b32 v12, a11
    ds_write_b32 v11, v12 offset:2816
    v_accvgpr_read_b32 v12, a12
    ds_write_b32 v11, v12 offset:3072
    v_accvgpr_read_b32 v12, a13
    ds_write_b32 v11, v12 offset:3328
    v_accvgpr_read_b32 v12, a14
    ds_write_b32 v11, v12 offset:3584
    v_accvgpr_read_b32 v12, a15
    ds_write_b32 v11, v12 offset:3840
    v_accvgpr_read_b32 v12, a16
    ds_write_b32 v11, v12 offset:4096
    v_accvgpr_read_b32 v12, a17
    ds_write_b32 v11, v12 offset:4352
    v_accvgpr_read_b32 v12, a18
    ds_write_b32 v11, v12 offset:4608
    v_accvgpr_read_b32 v12, a19
    ds_write_b32 v11, v12 offset:4864
    v_accvgpr_read_b32 v12, a20
    ds_write_b32 v11, v12 offset:5120
    v_accvgpr_read_b32 v12, a21
    ds_write_b32 v11, v12 offset:5376
    v_accvgpr_read_b32 v12, a22
    ds_write_b32 v11, v12 offset:5632
    v_accvgpr_read_b32 v12, a23
    ds_write_b32 v11, v12 offset:5888
    v_accvgpr_read_b32 v12, a24
    ds_write_b32 v11, v12 offset:6144
    v_accvgpr_read_b32 v12, a25
    ds_write_b32 v11, v12 offset:6400
    v_accvgpr_read_b32 v12, a26
    ds_write_b32 v11, v12 offset:6656
    v_accvgpr_read_b32 v12, a27
    ds_write_b32 v11, v12 offset:6912
    v_accvgpr_read_b32 v12, a28
    ds_write_b32 v11, v12 offset:7168
    v_accvgpr_read_b32 v12, a29
    ds_write_b32 v11, v12 offset:7424
    v_accvgpr_read_b32 v12, a30
    ds_write_b32 v11, v12 offset:7680
    v_accvgpr_read_b32 v12, a31
    ds_write_b32 v11, v12 offset:7936
    v_accvgpr_read_b32 v12, a32
    ds_write_b32 v11, v12 offset:8192
    v_accvgpr_read_b32 v12, a33
    ds_write_b32 v11, v12 offset:8448
    v_accvgpr_read_b32 v12, a34
    ds_write_b32 v11, v12 offset:8704
    v_accvgpr_read_b32 v12, a35
    ds_write_b32 v11, v12 offset:8960
    v_accvgpr_read_b32 v12, a36
    ds_write_b32 v11, v12 offset:9216
    v_accvgpr_read_b32 v12, a37
    ds_write_b32 v11, v12 offset:9472
    v_accvgpr_read_b32 v12, a38
    ds_write_b32 v11, v12 offset:9728
    v_accvgpr_read_b32 v12, a39
    ds_write_b32 v11, v12 offset:9984
    v_accvgpr_read_b32 v12, a40
    ds_write_b32 v11, v12 offset:10240
    v_accvgpr_read_b32 v12, a41
    ds_write_b32 v11, v12 offset:10496
    v_accvgpr_read_b32 v12, a42
    ds_write_b32 v11, v12 offset:10752
    v_accvgpr_read_b32 v12, a43
    ds_write_b32 v11, v12 offset:11008
    v_accvgpr_read_b32 v12, a44
    ds_write_b32 v11, v12 offset:11264
    v_accvgpr_read_b32 v12, a45
    ds_write_b32 v11, v12 offset:11520
    v_accvgpr_read_b32 v12, a46
    ds_write_b32 v11, v12 offset:11776
    v_accvgpr_read_b32 v12, a47
    ds_write_b32 v11, v12 offset:12032
    v_accvgpr_read_b32 v12, a48
    ds_write_b32 v11, v12 offset:12288
    v_accvgpr_read_b32 v12, a49
    ds_write_b32 v11, v12 offset:12544
    v_accvgpr_read_b32 v12, a50
    ds_write_b32 v11, v12 offset:12800
    v_accvgpr_read_b32 v12, a51
    ds_write_b32 v11, v12 offset:13056
    v_accvgpr_read_b32 v12, a52
    ds_write_b32 v11, v12 offset:13312
    v_accvgpr_read_b32 v12, a53
    ds_write_b32 v11, v12 offset:13568
    v_accvgpr_read_b32 v12, a54
    ds_write_b32 v11, v12 offset:13824
    v_accvgpr_read_b32 v12, a55
    ds_write_b32 v11, v12 offset:14080
    s_waitcnt lgkmcnt(0)
    s_barrier
    v_add_u32 v13, s28, v7
    v_mul_u32_u24 v13, 896, v13
    v_lshl_add_u32 v13, v8, 3, v13
    s_mul_i32 s30, s27, 448
    v_add_u32 v13, s30, v13
    s_lshl_b32 s30, s3, 5
    v_add_u32 v13, s30, v13
    s_lshl_b32 s30, s3, 10
    v_add_u32 v10, s30, v10
    v_add_u32 v11, 57344, v10
    buffer_load_dwordx2 v[24:25], v13, s[8:11], 0 offen offset:0
    ds_read_b32 v28, v10 offset:0
    ds_read_b32 v29, v10 offset:256
    ds_read_b32 v30, v10 offset:512
    ds_read_b32 v31, v10 offset:768
    ds_read_b32 v32, v10 offset:14336
    ds_read_b32 v33, v10 offset:14592
    ds_read_b32 v34, v10 offset:14848
    ds_read_b32 v35, v10 offset:15104
    ds_read_b32 v36, v10 offset:28672
    ds_read_b32 v37, v10 offset:28928
    ds_read_b32 v38, v10 offset:29184
    ds_read_b32 v39, v10 offset:29440
    ds_read_b32 v40, v10 offset:43008
    ds_read_b32 v41, v10 offset:43264
    ds_read_b32 v42, v10 offset:43520
    ds_read_b32 v43, v10 offset:43776
    ds_read_b32 v44, v11 offset:0
    ds_read_b32 v45, v11 offset:256
    ds_read_b32 v46, v11 offset:512
    ds_read_b32 v47, v11 offset:768
    ds_read_b32 v48, v11 offset:14336
    ds_read_b32 v49, v11 offset:14592
    ds_read_b32 v50, v11 offset:14848
    ds_read_b32 v51, v11 offset:15104
    ds_read_b32 v52, v11 offset:28672
    ds_read_b32 v53, v11 offset:28928
    ds_read_b32 v54, v11 offset:29184
    ds_read_b32 v55, v11 offset:29440
    ds_read_b32 v56, v11 offset:43008
    ds_read_b32 v57, v11 offset:43264
    ds_read_b32 v58, v11 offset:43520
    ds_read_b32 v59, v11 offset:43776
    s_waitcnt lgkmcnt(0)
    s_waitcnt vmcnt(0)
    v_add_f32 v28, v28, v32
    v_add_f32 v36, v36, v40
    v_add_f32 v44, v44, v48
    v_add_f32 v52, v52, v56
    v_add_f32 v28, v28, v36
    v_add_f32 v44, v44, v52
    v_add_f32 v28, v28, v44
    v_add_f32 v29, v29, v33
    v_add_f32 v37, v37, v41
    v_add_f32 v45, v45, v49
    v_add_f32 v53, v53, v57
    v_add_f32 v29, v29, v37
    v_add_f32 v45, v45, v53
    v_add_f32 v29, v29, v45
    v_add_f32 v30, v30, v34
    v_add_f32 v38, v38, v42
    v_add_f32 v46, v46, v50
    v_add_f32 v54, v54, v58
    v_add_f32 v30, v30, v38
    v_add_f32 v46, v46, v54
    v_add_f32 v30, v30, v46
    v_add_f32 v31, v31, v35
    v_add_f32 v39, v39, v43
    v_add_f32 v47, v47, v51
    v_add_f32 v55, v55, v59
    v_add_f32 v31, v31, v39
    v_add_f32 v47, v47, v55
    v_add_f32 v31, v31, v47
    v_lshlrev_b32 v32, 16, v24
    v_and_b32 v33, 0xffff0000, v24
    v_lshlrev_b32 v34, 16, v25
    v_and_b32 v35, 0xffff0000, v25
    v_add_f32 v28, v28, v32
    v_add_f32 v29, v29, v33
    v_add_f32 v30, v30, v34
    v_add_f32 v31, v31, v35
    v_cvt_pk_bf16_f32 v36, v28, v29
    v_cvt_pk_bf16_f32 v37, v30, v31
    buffer_store_dwordx2 v[36:37], v13, s[32:35], 0 offen offset:0
    s_nop 1
    s_cmp_ge_u32 s3, 6
    s_cbranch_scc1 k2_kernel_end
    buffer_load_dwordx2 v[24:25], v13, s[8:11], 0 offen offset:256
    ds_read_b32 v28, v10 offset:8192
    ds_read_b32 v29, v10 offset:8448
    ds_read_b32 v30, v10 offset:8704
    ds_read_b32 v31, v10 offset:8960
    ds_read_b32 v32, v10 offset:22528
    ds_read_b32 v33, v10 offset:22784
    ds_read_b32 v34, v10 offset:23040
    ds_read_b32 v35, v10 offset:23296
    ds_read_b32 v36, v10 offset:36864
    ds_read_b32 v37, v10 offset:37120
    ds_read_b32 v38, v10 offset:37376
    ds_read_b32 v39, v10 offset:37632
    ds_read_b32 v40, v10 offset:51200
    ds_read_b32 v41, v10 offset:51456
    ds_read_b32 v42, v10 offset:51712
    ds_read_b32 v43, v10 offset:51968
    ds_read_b32 v44, v11 offset:8192
    ds_read_b32 v45, v11 offset:8448
    ds_read_b32 v46, v11 offset:8704
    ds_read_b32 v47, v11 offset:8960
    ds_read_b32 v48, v11 offset:22528
    ds_read_b32 v49, v11 offset:22784
    ds_read_b32 v50, v11 offset:23040
    ds_read_b32 v51, v11 offset:23296
    ds_read_b32 v52, v11 offset:36864
    ds_read_b32 v53, v11 offset:37120
    ds_read_b32 v54, v11 offset:37376
    ds_read_b32 v55, v11 offset:37632
    ds_read_b32 v56, v11 offset:51200
    ds_read_b32 v57, v11 offset:51456
    ds_read_b32 v58, v11 offset:51712
    ds_read_b32 v59, v11 offset:51968
    s_waitcnt lgkmcnt(0)
    s_waitcnt vmcnt(0)
    v_add_f32 v28, v28, v32
    v_add_f32 v36, v36, v40
    v_add_f32 v44, v44, v48
    v_add_f32 v52, v52, v56
    v_add_f32 v28, v28, v36
    v_add_f32 v44, v44, v52
    v_add_f32 v28, v28, v44
    v_add_f32 v29, v29, v33
    v_add_f32 v37, v37, v41
    v_add_f32 v45, v45, v49
    v_add_f32 v53, v53, v57
    v_add_f32 v29, v29, v37
    v_add_f32 v45, v45, v53
    v_add_f32 v29, v29, v45
    v_add_f32 v30, v30, v34
    v_add_f32 v38, v38, v42
    v_add_f32 v46, v46, v50
    v_add_f32 v54, v54, v58
    v_add_f32 v30, v30, v38
    v_add_f32 v46, v46, v54
    v_add_f32 v30, v30, v46
    v_add_f32 v31, v31, v35
    v_add_f32 v39, v39, v43
    v_add_f32 v47, v47, v51
    v_add_f32 v55, v55, v59
    v_add_f32 v31, v31, v39
    v_add_f32 v47, v47, v55
    v_add_f32 v31, v31, v47
    v_lshlrev_b32 v32, 16, v24
    v_and_b32 v33, 0xffff0000, v24
    v_lshlrev_b32 v34, 16, v25
    v_and_b32 v35, 0xffff0000, v25
    v_add_f32 v28, v28, v32
    v_add_f32 v29, v29, v33
    v_add_f32 v30, v30, v34
    v_add_f32 v31, v31, v35
    v_cvt_pk_bf16_f32 v36, v28, v29
    v_cvt_pk_bf16_f32 v37, v30, v31
    buffer_store_dwordx2 v[36:37], v13, s[32:35], 0 offen offset:256
    s_nop 1
k2_kernel_end:
    s_endpgm
.globl k3_kernel
.p2align 8
.type k3_kernel,@function
k3_kernel:
    s_load_dwordx2 s[4:5], s[0:1], 32
    s_load_dwordx2 s[6:7], s[0:1], 40
    s_load_dwordx2 s[20:21], s[0:1], 72
    s_cmp_ge_u32 s2, 224
    s_cbranch_scc1 k3_kernel_end
    v_lshrrev_b32 v2, 6, v0
    v_and_b32 v1, 63, v0
    s_nop 0
    v_readfirstlane_b32 s3, v2
    s_waitcnt lgkmcnt(0)
    s_add_u32 s8, s20, 0x600000
    s_addc_u32 s9, s21, 0
    s_mov_b32 s10, 0x1c0000
    s_mov_b32 s11, 0x00020000
    s_mov_b32 s12, s4
    s_mov_b32 s13, s5
    s_mov_b32 s14, 0x188000
    s_mov_b32 s15, 0x00020000
    s_mov_b32 s44, s6
    s_mov_b32 s45, s7
    s_mov_b32 s46, 0x188000
    s_mov_b32 s47, 0x00020000
    s_add_u32 s16, s20, 0x800000
    s_addc_u32 s17, s21, 0
    s_mov_b32 s18, 0x700000
    s_mov_b32 s19, 0x00020000
    s_and_b32 s24, s2, 7
    s_lshr_b32 s25, s2, 3
    s_cmp_ge_u32 s25, 14
    s_cselect_b32 s26, 1, 0
    s_mul_i32 s27, s26, 14
    s_sub_u32 s27, s25, s27
    s_lshl_b32 s24, s24, 1
    s_add_u32 s24, s24, s26
    s_lshl_b32 s36, s24, 7
    s_and_b32 s34, s3, 3
    s_lshr_b32 s35, s3, 2
    s_lshl_b32 s37, s34, 5
    s_add_u32 s28, s36, s37
    v_lshrrev_b32 v2, 4, v1
    v_mul_u32_u24 v2, 3584, v2
    v_and_b32 v3, 15, v1
    v_lshrrev_b32 v4, 4, v1
    s_and_b32 s38, s3, 1
    s_lshl_b32 s38, s38, 2
    v_or_b32 v4, s38, v4
    v_lshlrev_b32 v4, 1, v4
    v_xor_b32 v3, v4, v3
    v_lshl_add_u32 v2, v3, 4, v2
    s_lshl_b32 s38, s27, 8
    s_mul_i32 s39, s34, 28672
    s_add_u32 s38, s38, s39
    s_lshl_b32 s39, s3, 11
    s_cmp_eq_u32 s35, 0
    s_cselect_b32 s60, s12, s44
    s_cselect_b32 s61, s13, s45
    s_mov_b32 s62, 0x188000
    s_mov_b32 s63, 0x00020000
    v_lshrrev_b32 v5, 4, v1
    v_bfe_u32 v6, v1, 2, 2
    v_lshl_add_u32 v5, v5, 3, v6
    v_mul_u32_u24 v5, 256, v5
    v_and_b32 v6, 3, v1
    v_lshl_add_u32 v5, v6, 3, v5
    s_lshl_b32 s29, s35, 7
    v_bfe_u32 v8, v1, 4, 1
    v_bfe_u32 v9, v1, 2, 2
    v_lshl_add_u32 v8, v8, 2, v9
    v_lshlrev_b32 v8, 5, v8
    v_and_b32 v9, 31, v5
    v_sub_u32 v10, v5, v9
    v_add_u32 v11, 0, v9
    v_add_u32 v11, s29, v11
    v_xor_b32 v11, v8, v11
    v_add_u32 v144, v10, v11
    v_add_u32 v148, 65536, v144
    v_add_u32 v152, 131072, v144
    v_add_u32 v11, 32, v9
    v_add_u32 v11, s29, v11
    v_xor_b32 v11, v8, v11
    v_add_u32 v145, v10, v11
    v_add_u32 v149, 65536, v145
    v_add_u32 v153, 131072, v145
    v_add_u32 v11, 64, v9
    v_add_u32 v11, s29, v11
    v_xor_b32 v11, v8, v11
    v_add_u32 v146, v10, v11
    v_add_u32 v150, 65536, v146
    v_add_u32 v154, 131072, v146
    v_add_u32 v11, 96, v9
    v_add_u32 v11, s29, v11
    v_xor_b32 v11, v8, v11
    v_add_u32 v147, v10, v11
    v_add_u32 v151, 65536, v147
    v_add_u32 v155, 131072, v147
    v_lshlrev_b32 v4, 4, v1
    s_mul_i32 s30, s3, 16
    s_add_u32 s31, s36, s30
    s_mul_i32 s31, s31, 896
    s_mul_i32 s30, s30, 912
    s_mov_b32 exec_hi, 0x00ffffff
    s_mov_b32 m0, s30
    s_nop 0
    buffer_load_dwordx4 v4, s[8:11], s31 offen lds
    s_add_u32 s30, s30, 912
    s_add_u32 s31, s31, 896
    s_mov_b32 m0, s30
    s_nop 0
    buffer_load_dwordx4 v4, s[8:11], s31 offen lds
    s_add_u32 s30, s30, 912
    s_add_u32 s31, s31, 896
    s_mov_b32 m0, s30
    s_nop 0
    buffer_load_dwordx4 v4, s[8:11], s31 offen lds
    s_add_u32 s30, s30, 912
    s_add_u32 s31, s31, 896
    s_mov_b32 m0, s30
    s_nop 0
    buffer_load_dwordx4 v4, s[8:11], s31 offen lds
    s_add_u32 s30, s30, 912
    s_add_u32 s31, s31, 896
    s_mov_b32 m0, s30
    s_nop 0
    buffer_load_dwordx4 v4, s[8:11], s31 offen lds
    s_add_u32 s30, s30, 912
    s_add_u32 s31, s31, 896
    s_mov_b32 m0, s30
    s_nop 0
    buffer_load_dwordx4 v4, s[8:11], s31 offen lds
    s_add_u32 s30, s30, 912
    s_add_u32 s31, s31, 896
    s_mov_b32 m0, s30
    s_nop 0
    buffer_load_dwordx4 v4, s[8:11], s31 offen lds
    s_add_u32 s30, s30, 912
    s_add_u32 s31, s31, 896
    s_mov_b32 m0, s30
    s_nop 0
    buffer_load_dwordx4 v4, s[8:11], s31 offen lds
    s_add_u32 s30, s30, 912
    s_add_u32 s31, s31, 896
    s_mov_b32 m0, s30
    s_nop 0
    buffer_load_dwordx4 v4, s[8:11], s31 offen lds
    s_add_u32 s30, s30, 912
    s_add_u32 s31, s31, 896
    s_mov_b32 m0, s30
    s_nop 0
    buffer_load_dwordx4 v4, s[8:11], s31 offen lds
    s_add_u32 s30, s30, 912
    s_add_u32 s31, s31, 896
    s_mov_b32 m0, s30
    s_nop 0
    buffer_load_dwordx4 v4, s[8:11], s31 offen lds
    s_add_u32 s30, s30, 912
    s_add_u32 s31, s31, 896
    s_mov_b32 m0, s30
    s_nop 0
    buffer_load_dwordx4 v4, s[8:11], s31 offen lds
    s_add_u32 s30, s30, 912
    s_add_u32 s31, s31, 896
    s_mov_b32 m0, s30
    s_nop 0
    buffer_load_dwordx4 v4, s[8:11], s31 offen lds
    s_add_u32 s30, s30, 912
    s_add_u32 s31, s31, 896
    s_mov_b32 m0, s30
    s_nop 0
    buffer_load_dwordx4 v4, s[8:11], s31 offen lds
    s_add_u32 s30, s30, 912
    s_add_u32 s31, s31, 896
    s_mov_b32 m0, s30
    s_nop 0
    buffer_load_dwordx4 v4, s[8:11], s31 offen lds
    s_add_u32 s30, s30, 912
    s_add_u32 s31, s31, 896
    s_mov_b32 m0, s30
    s_nop 0
    buffer_load_dwordx4 v4, s[8:11], s31 offen lds
    s_add_u32 s30, s30, 912
    s_add_u32 s31, s31, 896
    s_mov_b32 exec_hi, -1
    s_add_u32 s30, s39, 131072
    s_mov_b32 m0, s30
    s_add_u32 s31, s38, 0
    buffer_load_dwordx4 v2, s[60:63], s31 offen lds
    s_add_u32 s30, s39, 132096
    s_mov_b32 m0, s30
    s_add_u32 s31, s38, 14336
    buffer_load_dwordx4 v2, s[60:63], s31 offen lds
    s_add_u32 s30, s39, 147456
    s_mov_b32 m0, s30
    s_add_u32 s31, s38, 114688
    buffer_load_dwordx4 v2, s[60:63], s31 offen lds
    s_add_u32 s30, s39, 148480
    s_mov_b32 m0, s30
    s_add_u32 s31, s38, 129024
    buffer_load_dwordx4 v2, s[60:63], s31 offen lds
    v_accvgpr_write_b32 a0, 0
    v_accvgpr_write_b32 a1, 0
    v_accvgpr_write_b32 a2, 0
    v_accvgpr_write_b32 a3, 0
    v_accvgpr_write_b32 a4, 0
    v_accvgpr_write_b32 a5, 0
    v_accvgpr_write_b32 a6, 0
    v_accvgpr_write_b32 a7, 0
    v_accvgpr_write_b32 a8, 0
    v_accvgpr_write_b32 a9, 0
    v_accvgpr_write_b32 a10, 0
    v_accvgpr_write_b32 a11, 0
    v_accvgpr_write_b32 a12, 0
    v_accvgpr_write_b32 a13, 0
    v_accvgpr_write_b32 a14, 0
    v_accvgpr_write_b32 a15, 0
    v_accvgpr_write_b32 a16, 0
    v_accvgpr_write_b32 a17, 0
    v_accvgpr_write_b32 a18, 0
    v_accvgpr_write_b32 a19, 0
    v_accvgpr_write_b32 a20, 0
    v_accvgpr_write_b32 a21, 0
    v_accvgpr_write_b32 a22, 0
    v_accvgpr_write_b32 a23, 0
    v_accvgpr_write_b32 a24, 0
    v_accvgpr_write_b32 a25, 0
    v_accvgpr_write_b32 a26, 0
    v_accvgpr_write_b32 a27, 0
    v_accvgpr_write_b32 a28, 0
    v_accvgpr_write_b32 a29, 0
    v_accvgpr_write_b32 a30, 0
    v_accvgpr_write_b32 a31, 0
    v_accvgpr_write_b32 a32, 0
    v_accvgpr_write_b32 a33, 0
    v_accvgpr_write_b32 a34, 0
    v_accvgpr_write_b32 a35, 0
    v_accvgpr_write_b32 a36, 0
    v_accvgpr_write_b32 a37, 0
    v_accvgpr_write_b32 a38, 0
    v_accvgpr_write_b32 a39, 0
    v_accvgpr_write_b32 a40, 0
    v_accvgpr_write_b32 a41, 0
    v_accvgpr_write_b32 a42, 0
    v_accvgpr_write_b32 a43, 0
    v_accvgpr_write_b32 a44, 0
    v_accvgpr_write_b32 a45, 0
    v_accvgpr_write_b32 a46, 0
    v_accvgpr_write_b32 a47, 0
    v_accvgpr_write_b32 a48, 0
    v_accvgpr_write_b32 a49, 0
    v_accvgpr_write_b32 a50, 0
    v_accvgpr_write_b32 a51, 0
    v_accvgpr_write_b32 a52, 0
    v_accvgpr_write_b32 a53, 0
    v_accvgpr_write_b32 a54, 0
    v_accvgpr_write_b32 a55, 0
    v_accvgpr_write_b32 a56, 0
    v_accvgpr_write_b32 a57, 0
    v_accvgpr_write_b32 a58, 0
    v_accvgpr_write_b32 a59, 0
    v_accvgpr_write_b32 a60, 0
    v_accvgpr_write_b32 a61, 0
    v_accvgpr_write_b32 a62, 0
    v_accvgpr_write_b32 a63, 0
    v_and_b32 v3, 15, v1
    v_add_u32 v3, s37, v3
    v_mul_u32_u24 v3, 912, v3
    v_lshrrev_b32 v4, 4, v1
    v_lshl_add_u32 v3, v4, 4, v3
    s_waitcnt vmcnt(4)
    s_barrier
    v_lshrrev_b32 v8, 3, v1
    s_mul_i32 s30, s3, 16
    v_add_u32 v8, s30, v8
    v_mul_u32_u24 v8, 912, v8
    v_and_b32 v9, 7, v1
    v_mul_u32_u24 v9, 112, v9
    v_add_u32 v8, v8, v9
    s_mov_b32 s40, 0x3f803f80
    ds_read_b128 v[16:19], v8 offset:0
    ds_read_b128 v[20:23], v8 offset:16
    ds_read_b128 v[24:27], v8 offset:32
    ds_read_b128 v[28:31], v8 offset:48
    ds_read_b128 v[32:35], v8 offset:64
    ds_read_b128 v[36:39], v8 offset:80
    ds_read_b128 v[40:43], v8 offset:96
    v_mov_b32 v48, 0
    v_mov_b32 v49, 0
    v_mov_b32 v50, 0
    v_mov_b32 v51, 0
    s_waitcnt lgkmcnt(0)
    v_dot2_f32_bf16 v48, v16, s40, v48
    v_dot2_f32_bf16 v50, v16, v16, v50
    v_dot2_f32_bf16 v49, v17, s40, v49
    v_dot2_f32_bf16 v51, v17, v17, v51
    v_dot2_f32_bf16 v48, v18, s40, v48
    v_dot2_f32_bf16 v50, v18, v18, v50
    v_dot2_f32_bf16 v49, v19, s40, v49
    v_dot2_f32_bf16 v51, v19, v19, v51
    v_dot2_f32_bf16 v48, v20, s40, v48
    v_dot2_f32_bf16 v50, v20, v20, v50
    v_dot2_f32_bf16 v49, v21, s40, v49
    v_dot2_f32_bf16 v51, v21, v21, v51
    v_dot2_f32_bf16 v48, v22, s40, v48
    v_dot2_f32_bf16 v50, v22, v22, v50
    v_dot2_f32_bf16 v49, v23, s40, v49
    v_dot2_f32_bf16 v51, v23, v23, v51
    v_dot2_f32_bf16 v48, v24, s40, v48
    v_dot2_f32_bf16 v50, v24, v24, v50
    v_dot2_f32_bf16 v49, v25, s40, v49
    v_dot2_f32_bf16 v51, v25, v25, v51
    v_dot2_f32_bf16 v48, v26, s40, v48
    v_dot2_f32_bf16 v50, v26, v26, v50
    v_dot2_f32_bf16 v49, v27, s40, v49
    v_dot2_f32_bf16 v51, v27, v27, v51
    v_dot2_f32_bf16 v48, v28, s40, v48
    v_dot2_f32_bf16 v50, v28, v28, v50
    v_dot2_f32_bf16 v49, v29, s40, v49
    v_dot2_f32_bf16 v51, v29, v29, v51
    v_dot2_f32_bf16 v48, v30, s40, v48
    v_dot2_f32_bf16 v50, v30, v30, v50
    v_dot2_f32_bf16 v49, v31, s40, v49
    v_dot2_f32_bf16 v51, v31, v31, v51
    v_dot2_f32_bf16 v48, v32, s40, v48
    v_dot2_f32_bf16 v50, v32, v32, v50
    v_dot2_f32_bf16 v49, v33, s40, v49
    v_dot2_f32_bf16 v51, v33, v33, v51
    v_dot2_f32_bf16 v48, v34, s40, v48
    v_dot2_f32_bf16 v50, v34, v34, v50
    v_dot2_f32_bf16 v49, v35, s40, v49
    v_dot2_f32_bf16 v51, v35, v35, v51
    v_dot2_f32_bf16 v48, v36, s40, v48
    v_dot2_f32_bf16 v50, v36, v36, v50
    v_dot2_f32_bf16 v49, v37, s40, v49
    v_dot2_f32_bf16 v51, v37, v37, v51
    v_dot2_f32_bf16 v48, v38, s40, v48
    v_dot2_f32_bf16 v50, v38, v38, v50
    v_dot2_f32_bf16 v49, v39, s40, v49
    v_dot2_f32_bf16 v51, v39, v39, v51
    v_dot2_f32_bf16 v48, v40, s40, v48
    v_dot2_f32_bf16 v50, v40, v40, v50
    v_dot2_f32_bf16 v49, v41, s40, v49
    v_dot2_f32_bf16 v51, v41, v41, v51
    v_dot2_f32_bf16 v48, v42, s40, v48
    v_dot2_f32_bf16 v50, v42, v42, v50
    v_dot2_f32_bf16 v49, v43, s40, v49
    v_dot2_f32_bf16 v51, v43, v43, v51
    s_nop 3
    v_add_f32 v48, v48, v49
    v_add_f32 v50, v50, v51
    s_nop 1
    v_add_f32_dpp v49, v48, v48 quad_perm:[1,0,3,2] row_mask:0xf bank_mask:0xf
    v_add_f32_dpp v51, v50, v50 quad_perm:[1,0,3,2] row_mask:0xf bank_mask:0xf
    v_mov_b32 v48, v49
    v_mov_b32 v50, v51
    s_nop 1
    v_add_f32_dpp v49, v48, v48 quad_perm:[2,3,0,1] row_mask:0xf bank_mask:0xf
    v_add_f32_dpp v51, v50, v50 quad_perm:[2,3,0,1] row_mask:0xf bank_mask:0xf
    v_mov_b32 v48, v49
    v_mov_b32 v50, v51
    s_nop 1
    v_add_f32_dpp v49, v48, v48 row_half_mirror row_mask:0xf bank_mask:0xf
    v_add_f32_dpp v51, v50, v50 row_half_mirror row_mask:0xf bank_mask:0xf
    v_mov_b32 v48, v49
    v_mov_b32 v50, v51
    v_mul_f32 v52, 0x3b124925, v48
    v_mul_f32 v50, 0x3b124925, v50
    v_fma_f32 v50, -v52, v52, v50
    v_add_f32 v50, 0x3727c5ac, v50
    v_rsq_f32 v53, v50
    s_nop 0
    v_mul_f32 v52, v52, v53
    v_sub_f32 v52, 0, v52
    v_lshlrev_b32 v54, 16, v16
    v_and_b32 v55, 0xffff0000, v16
    v_fma_f32 v54, v54, v53, v52
    v_fma_f32 v55, v55, v53, v52
    v_cvt_pk_bf16_f32 v16, v54, v55
    v_lshlrev_b32 v54, 16, v17
    v_and_b32 v55, 0xffff0000, v17
    v_fma_f32 v54, v54, v53, v52
    v_fma_f32 v55, v55, v53, v52
    v_cvt_pk_bf16_f32 v17, v54, v55
    v_lshlrev_b32 v54, 16, v18
    v_and_b32 v55, 0xffff0000, v18
    v_fma_f32 v54, v54, v53, v52
    v_fma_f32 v55, v55, v53, v52
    v_cvt_pk_bf16_f32 v18, v54, v55
    v_lshlrev_b32 v54, 16, v19
    v_and_b32 v55, 0xffff0000, v19
    v_fma_f32 v54, v54, v53, v52
    v_fma_f32 v55, v55, v53, v52
    v_cvt_pk_bf16_f32 v19, v54, v55
    v_lshlrev_b32 v54, 16, v20
    v_and_b32 v55, 0xffff0000, v20
    v_fma_f32 v54, v54, v53, v52
    v_fma_f32 v55, v55, v53, v52
    v_cvt_pk_bf16_f32 v20, v54, v55
    v_lshlrev_b32 v54, 16, v21
    v_and_b32 v55, 0xffff0000, v21
    v_fma_f32 v54, v54, v53, v52
    v_fma_f32 v55, v55, v53, v52
    v_cvt_pk_bf16_f32 v21, v54, v55
    v_lshlrev_b32 v54, 16, v22
    v_and_b32 v55, 0xffff0000, v22
    v_fma_f32 v54, v54, v53, v52
    v_fma_f32 v55, v55, v53, v52
    v_cvt_pk_bf16_f32 v22, v54, v55
    v_lshlrev_b32 v54, 16, v23
    v_and_b32 v55, 0xffff0000, v23
    v_fma_f32 v54, v54, v53, v52
    v_fma_f32 v55, v55, v53, v52
    v_cvt_pk_bf16_f32 v23, v54, v55
    v_lshlrev_b32 v54, 16, v24
    v_and_b32 v55, 0xffff0000, v24
    v_fma_f32 v54, v54, v53, v52
    v_fma_f32 v55, v55, v53, v52
    v_cvt_pk_bf16_f32 v24, v54, v55
    v_lshlrev_b32 v54, 16, v25
    v_and_b32 v55, 0xffff0000, v25
    v_fma_f32 v54, v54, v53, v52
    v_fma_f32 v55, v55, v53, v52
    v_cvt_pk_bf16_f32 v25, v54, v55
    v_lshlrev_b32 v54, 16, v26
    v_and_b32 v55, 0xffff0000, v26
    v_fma_f32 v54, v54, v53, v52
    v_fma_f32 v55, v55, v53, v52
    v_cvt_pk_bf16_f32 v26, v54, v55
    v_lshlrev_b32 v54, 16, v27
    v_and_b32 v55, 0xffff0000, v27
    v_fma_f32 v54, v54, v53, v52
    v_fma_f32 v55, v55, v53, v52
    v_cvt_pk_bf16_f32 v27, v54, v55
    v_lshlrev_b32 v54, 16, v28
    v_and_b32 v55, 0xffff0000, v28
    v_fma_f32 v54, v54, v53, v52
    v_fma_f32 v55, v55, v53, v52
    v_cvt_pk_bf16_f32 v28, v54, v55
    v_lshlrev_b32 v54, 16, v29
    v_and_b32 v55, 0xffff0000, v29
    v_fma_f32 v54, v54, v53, v52
    v_fma_f32 v55, v55, v53, v52
    v_cvt_pk_bf16_f32 v29, v54, v55
    v_lshlrev_b32 v54, 16, v30
    v_and_b32 v55, 0xffff0000, v30
    v_fma_f32 v54, v54, v53, v52
    v_fma_f32 v55, v55, v53, v52
    v_cvt_pk_bf16_f32 v30, v54, v55
    v_lshlrev_b32 v54, 16, v31
    v_and_b32 v55, 0xffff0000, v31
    v_fma_f32 v54, v54, v53, v52
    v_fma_f32 v55, v55, v53, v52
    v_cvt_pk_bf16_f32 v31, v54, v55
    v_lshlrev_b32 v54, 16, v32
    v_and_b32 v55, 0xffff0000, v32
    v_fma_f32 v54, v54, v53, v52
    v_fma_f32 v55, v55, v53, v52
    v_cvt_pk_bf16_f32 v32, v54, v55
    v_lshlrev_b32 v54, 16, v33
    v_and_b32 v55, 0xffff0000, v33
    v_fma_f32 v54, v54, v53, v52
    v_fma_f32 v55, v55, v53, v52
    v_cvt_pk_bf16_f32 v33, v54, v55
    v_lshlrev_b32 v54, 16, v34
    v_and_b32 v55, 0xffff0000, v34
    v_fma_f32 v54, v54, v53, v52
    v_fma_f32 v55, v55, v53, v52
    v_cvt_pk_bf16_f32 v34, v54, v55
    v_lshlrev_b32 v54, 16, v35
    v_and_b32 v55, 0xffff0000, v35
    v_fma_f32 v54, v54, v53, v52
    v_fma_f32 v55, v55, v53, v52
    v_cvt_pk_bf16_f32 v35, v54, v55
    v_lshlrev_b32 v54, 16, v36
    v_and_b32 v55, 0xffff0000, v36
    v_fma_f32 v54, v54, v53, v52
    v_fma_f32 v55, v55, v53, v52
    v_cvt_pk_bf16_f32 v36, v54, v55
    v_lshlrev_b32 v54, 16, v37
    v_and_b32 v55, 0xffff0000, v37
    v_fma_f32 v54, v54, v53, v52
    v_fma_f32 v55, v55, v53, v52
    v_cvt_pk_bf16_f32 v37, v54, v55
    v_lshlrev_b32 v54, 16, v38
    v_and_b32 v55, 0xffff0000, v38
    v_fma_f32 v54, v54, v53, v52
    v_fma_f32 v55, v55, v53, v52
    v_cvt_pk_bf16_f32 v38, v54, v55
    v_lshlrev_b32 v54, 16, v39
    v_and_b32 v55, 0xffff0000, v39
    v_fma_f32 v54, v54, v53, v52
    v_fma_f32 v55, v55, v53, v52
    v_cvt_pk_bf16_f32 v39, v54, v55
    v_lshlrev_b32 v54, 16, v40
    v_and_b32 v55, 0xffff0000, v40
    v_fma_f32 v54, v54, v53, v52
    v_fma_f32 v55, v55, v53, v52
    v_cvt_pk_bf16_f32 v40, v54, v55
    v_lshlrev_b32 v54, 16, v41
    v_and_b32 v55, 0xffff0000, v41
    v_fma_f32 v54, v54, v53, v52
    v_fma_f32 v55, v55, v53, v52
    v_cvt_pk_bf16_f32 v41, v54, v55
    v_lshlrev_b32 v54, 16, v42
    v_and_b32 v55, 0xffff0000, v42
    v_fma_f32 v54, v54, v53, v52
    v_fma_f32 v55, v55, v53, v52
    v_cvt_pk_bf16_f32 v42, v54, v55
    v_lshlrev_b32 v54, 16, v43
    v_and_b32 v55, 0xffff0000, v43
    v_fma_f32 v54, v54, v53, v52
    v_fma_f32 v55, v55, v53, v52
    v_cvt_pk_bf16_f32 v43, v54, v55
    ds_write_b128 v8, v[16:19] offset:0
    ds_write_b128 v8, v[20:23] offset:16
    ds_write_b128 v8, v[24:27] offset:32
    ds_write_b128 v8, v[28:31] offset:48
    ds_write_b128 v8, v[32:35] offset:64
    ds_write_b128 v8, v[36:39] offset:80
    ds_write_b128 v8, v[40:43] offset:96
    s_waitcnt lgkmcnt(0)
    ds_read_b128 v[16:19], v8 offset:7296
    ds_read_b128 v[20:23], v8 offset:7312
    ds_read_b128 v[24:27], v8 offset:7328
    ds_read_b128 v[28:31], v8 offset:7344
    ds_read_b128 v[32:35], v8 offset:7360
    ds_read_b128 v[36:39], v8 offset:7376
    ds_read_b128 v[40:43], v8 offset:7392
    v_mov_b32 v48, 0
    v_mov_b32 v49, 0
    v_mov_b32 v50, 0
    v_mov_b32 v51, 0
    s_waitcnt lgkmcnt(0)
    v_dot2_f32_bf16 v48, v16, s40, v48
    v_dot2_f32_bf16 v50, v16, v16, v50
    v_dot2_f32_bf16 v49, v17, s40, v49
    v_dot2_f32_bf16 v51, v17, v17, v51
    v_dot2_f32_bf16 v48, v18, s40, v48
    v_dot2_f32_bf16 v50, v18, v18, v50
    v_dot2_f32_bf16 v49, v19, s40, v49
    v_dot2_f32_bf16 v51, v19, v19, v51
    v_dot2_f32_bf16 v48, v20, s40, v48
    v_dot2_f32_bf16 v50, v20, v20, v50
    v_dot2_f32_bf16 v49, v21, s40, v49
    v_dot2_f32_bf16 v51, v21, v21, v51
    v_dot2_f32_bf16 v48, v22, s40, v48
    v_dot2_f32_bf16 v50, v22, v22, v50
    v_dot2_f32_bf16 v49, v23, s40, v49
    v_dot2_f32_bf16 v51, v23, v23, v51
    v_dot2_f32_bf16 v48, v24, s40, v48
    v_dot2_f32_bf16 v50, v24, v24, v50
    v_dot2_f32_bf16 v49, v25, s40, v49
    v_dot2_f32_bf16 v51, v25, v25, v51
    v_dot2_f32_bf16 v48, v26, s40, v48
    v_dot2_f32_bf16 v50, v26, v26, v50
    v_dot2_f32_bf16 v49, v27, s40, v49
    v_dot2_f32_bf16 v51, v27, v27, v51
    v_dot2_f32_bf16 v48, v28, s40, v48
    v_dot2_f32_bf16 v50, v28, v28, v50
    v_dot2_f32_bf16 v49, v29, s40, v49
    v_dot2_f32_bf16 v51, v29, v29, v51
    v_dot2_f32_bf16 v48, v30, s40, v48
    v_dot2_f32_bf16 v50, v30, v30, v50
    v_dot2_f32_bf16 v49, v31, s40, v49
    v_dot2_f32_bf16 v51, v31, v31, v51
    v_dot2_f32_bf16 v48, v32, s40, v48
    v_dot2_f32_bf16 v50, v32, v32, v50
    v_dot2_f32_bf16 v49, v33, s40, v49
    v_dot2_f32_bf16 v51, v33, v33, v51
    v_dot2_f32_bf16 v48, v34, s40, v48
    v_dot2_f32_bf16 v50, v34, v34, v50
    v_dot2_f32_bf16 v49, v35, s40, v49
    v_dot2_f32_bf16 v51, v35, v35, v51
    v_dot2_f32_bf16 v48, v36, s40, v48
    v_dot2_f32_bf16 v50, v36, v36, v50
    v_dot2_f32_bf16 v49, v37, s40, v49
    v_dot2_f32_bf16 v51, v37, v37, v51
    v_dot2_f32_bf16 v48, v38, s40, v48
    v_dot2_f32_bf16 v50, v38, v38, v50
    v_dot2_f32_bf16 v49, v39, s40, v49
    v_dot2_f32_bf16 v51, v39, v39, v51
    v_dot2_f32_bf16 v48, v40, s40, v48
    v_dot2_f32_bf16 v50, v40, v40, v50
    v_dot2_f32_bf16 v49, v41, s40, v49
    v_dot2_f32_bf16 v51, v41, v41, v51
    v_dot2_f32_bf16 v48, v42, s40, v48
    v_dot2_f32_bf16 v50, v42, v42, v50
    v_dot2_f32_bf16 v49, v43, s40, v49
    v_dot2_f32_bf16 v51, v43, v43, v51
    s_nop 3
    v_add_f32 v48, v48, v49
    v_add_f32 v50, v50, v51
    s_nop 1
    v_add_f32_dpp v49, v48, v48 quad_perm:[1,0,3,2] row_mask:0xf bank_mask:0xf
    v_add_f32_dpp v51, v50, v50 quad_perm:[1,0,3,2] row_mask:0xf bank_mask:0xf
    v_mov_b32 v48, v49
    v_mov_b32 v50, v51
    s_nop 1
    v_add_f32_dpp v49, v48, v48 quad_perm:[2,3,0,1] row_mask:0xf bank_mask:0xf
    v_add_f32_dpp v51, v50, v50 quad_perm:[2,3,0,1] row_mask:0xf bank_mask:0xf
    v_mov_b32 v48, v49
    v_mov_b32 v50, v51
    s_nop 1
    v_add_f32_dpp v49, v48, v48 row_half_mirror row_mask:0xf bank_mask:0xf
    v_add_f32_dpp v51, v50, v50 row_half_mirror row_mask:0xf bank_mask:0xf
    v_mov_b32 v48, v49
    v_mov_b32 v50, v51
    v_mul_f32 v52, 0x3b124925, v48
    v_mul_f32 v50, 0x3b124925, v50
    v_fma_f32 v50, -v52, v52, v50
    v_add_f32 v50, 0x3727c5ac, v50
    v_rsq_f32 v53, v50
    s_nop 0
    v_mul_f32 v52, v52, v53
    v_sub_f32 v52, 0, v52
    v_lshlrev_b32 v54, 16, v16
    v_and_b32 v55, 0xffff0000, v16
    v_fma_f32 v54, v54, v53, v52
    v_fma_f32 v55, v55, v53, v52
    v_cvt_pk_bf16_f32 v16, v54, v55
    v_lshlrev_b32 v54, 16, v17
    v_and_b32 v55, 0xffff0000, v17
    v_fma_f32 v54, v54, v53, v52
    v_fma_f32 v55, v55, v53, v52
    v_cvt_pk_bf16_f32 v17, v54, v55
    v_lshlrev_b32 v54, 16, v18
    v_and_b32 v55, 0xffff0000, v18
    v_fma_f32 v54, v54, v53, v52
    v_fma_f32 v55, v55, v53, v52
    v_cvt_pk_bf16_f32 v18, v54, v55
    v_lshlrev_b32 v54, 16, v19
    v_and_b32 v55, 0xffff0000, v19
    v_fma_f32 v54, v54, v53, v52
    v_fma_f32 v55, v55, v53, v52
    v_cvt_pk_bf16_f32 v19, v54, v55
    v_lshlrev_b32 v54, 16, v20
    v_and_b32 v55, 0xffff0000, v20
    v_fma_f32 v54, v54, v53, v52
    v_fma_f32 v55, v55, v53, v52
    v_cvt_pk_bf16_f32 v20, v54, v55
    v_lshlrev_b32 v54, 16, v21
    v_and_b32 v55, 0xffff0000, v21
    v_fma_f32 v54, v54, v53, v52
    v_fma_f32 v55, v55, v53, v52
    v_cvt_pk_bf16_f32 v21, v54, v55
    v_lshlrev_b32 v54, 16, v22
    v_and_b32 v55, 0xffff0000, v22
    v_fma_f32 v54, v54, v53, v52
    v_fma_f32 v55, v55, v53, v52
    v_cvt_pk_bf16_f32 v22, v54, v55
    v_lshlrev_b32 v54, 16, v23
    v_and_b32 v55, 0xffff0000, v23
    v_fma_f32 v54, v54, v53, v52
    v_fma_f32 v55, v55, v53, v52
    v_cvt_pk_bf16_f32 v23, v54, v55
    v_lshlrev_b32 v54, 16, v24
    v_and_b32 v55, 0xffff0000, v24
    v_fma_f32 v54, v54, v53, v52
    v_fma_f32 v55, v55, v53, v52
    v_cvt_pk_bf16_f32 v24, v54, v55
    v_lshlrev_b32 v54, 16, v25
    v_and_b32 v55, 0xffff0000, v25
    v_fma_f32 v54, v54, v53, v52
    v_fma_f32 v55, v55, v53, v52
    v_cvt_pk_bf16_f32 v25, v54, v55
    v_lshlrev_b32 v54, 16, v26
    v_and_b32 v55, 0xffff0000, v26
    v_fma_f32 v54, v54, v53, v52
    v_fma_f32 v55, v55, v53, v52
    v_cvt_pk_bf16_f32 v26, v54, v55
    v_lshlrev_b32 v54, 16, v27
    v_and_b32 v55, 0xffff0000, v27
    v_fma_f32 v54, v54, v53, v52
    v_fma_f32 v55, v55, v53, v52
    v_cvt_pk_bf16_f32 v27, v54, v55
    v_lshlrev_b32 v54, 16, v28
    v_and_b32 v55, 0xffff0000, v28
    v_fma_f32 v54, v54, v53, v52
    v_fma_f32 v55, v55, v53, v52
    v_cvt_pk_bf16_f32 v28, v54, v55
    v_lshlrev_b32 v54, 16, v29
    v_and_b32 v55, 0xffff0000, v29
    v_fma_f32 v54, v54, v53, v52
    v_fma_f32 v55, v55, v53, v52
    v_cvt_pk_bf16_f32 v29, v54, v55
    v_lshlrev_b32 v54, 16, v30
    v_and_b32 v55, 0xffff0000, v30
    v_fma_f32 v54, v54, v53, v52
    v_fma_f32 v55, v55, v53, v52
    v_cvt_pk_bf16_f32 v30, v54, v55
    v_lshlrev_b32 v54, 16, v31
    v_and_b32 v55, 0xffff0000, v31
    v_fma_f32 v54, v54, v53, v52
    v_fma_f32 v55, v55, v53, v52
    v_cvt_pk_bf16_f32 v31, v54, v55
    v_lshlrev_b32 v54, 16, v32
    v_and_b32 v55, 0xffff0000, v32
    v_fma_f32 v54, v54, v53, v52
    v_fma_f32 v55, v55, v53, v52
    v_cvt_pk_bf16_f32 v32, v54, v55
    v_lshlrev_b32 v54, 16, v33
    v_and_b32 v55, 0xffff0000, v33
    v_fma_f32 v54, v54, v53, v52
    v_fma_f32 v55, v55, v53, v52
    v_cvt_pk_bf16_f32 v33, v54, v55
    v_lshlrev_b32 v54, 16, v34
    v_and_b32 v55, 0xffff0000, v34
    v_fma_f32 v54, v54, v53, v52
    v_fma_f32 v55, v55, v53, v52
    v_cvt_pk_bf16_f32 v34, v54, v55
    v_lshlrev_b32 v54, 16, v35
    v_and_b32 v55, 0xffff0000, v35
    v_fma_f32 v54, v54, v53, v52
    v_fma_f32 v55, v55, v53, v52
    v_cvt_pk_bf16_f32 v35, v54, v55
    v_lshlrev_b32 v54, 16, v36
    v_and_b32 v55, 0xffff0000, v36
    v_fma_f32 v54, v54, v53, v52
    v_fma_f32 v55, v55, v53, v52
    v_cvt_pk_bf16_f32 v36, v54, v55
    v_lshlrev_b32 v54, 16, v37
    v_and_b32 v55, 0xffff0000, v37
    v_fma_f32 v54, v54, v53, v52
    v_fma_f32 v55, v55, v53, v52
    v_cvt_pk_bf16_f32 v37, v54, v55
    v_lshlrev_b32 v54, 16, v38
    v_and_b32 v55, 0xffff0000, v38
    v_fma_f32 v54, v54, v53, v52
    v_fma_f32 v55, v55, v53, v52
    v_cvt_pk_bf16_f32 v38, v54, v55
    v_lshlrev_b32 v54, 16, v39
    v_and_b32 v55, 0xffff0000, v39
    v_fma_f32 v54, v54, v53, v52
    v_fma_f32 v55, v55, v53, v52
    v_cvt_pk_bf16_f32 v39, v54, v55
    v_lshlrev_b32 v54, 16, v40
    v_and_b32 v55, 0xffff0000, v40
    v_fma_f32 v54, v54, v53, v52
    v_fma_f32 v55, v55, v53, v52
    v_cvt_pk_bf16_f32 v40, v54, v55
    v_lshlrev_b32 v54, 16, v41
    v_and_b32 v55, 0xffff0000, v41
    v_fma_f32 v54, v54, v53, v52
    v_fma_f32 v55, v55, v53, v52
    v_cvt_pk_bf16_f32 v41, v54, v55
    v_lshlrev_b32 v54, 16, v42
    v_and_b32 v55, 0xffff0000, v42
    v_fma_f32 v54, v54, v53, v52
    v_fma_f32 v55, v55, v53, v52
    v_cvt_pk_bf16_f32 v42, v54, v55
    v_lshlrev_b32 v54, 16, v43
    v_and_b32 v55, 0xffff0000, v43
    v_fma_f32 v54, v54, v53, v52
    v_fma_f32 v55, v55, v53, v52
    v_cvt_pk_bf16_f32 v43, v54, v55
    ds_write_b128 v8, v[16:19] offset:7296
    ds_write_b128 v8, v[20:23] offset:7312
    ds_write_b128 v8, v[24:27] offset:7328
    ds_write_b128 v8, v[28:31] offset:7344
    ds_write_b128 v8, v[32:35] offset:7360
    ds_write_b128 v8, v[36:39] offset:7376
    ds_write_b128 v8, v[40:43] offset:7392
    s_waitcnt lgkmcnt(0)
    s_barrier
    ds_read_b128 v[16:19], v3 offset:0
    ds_read_b128 v[20:23], v3 offset:64
    ds_read_b128 v[24:27], v3 offset:128
    ds_read_b128 v[28:31], v3 offset:192
    ds_read_b128 v[32:35], v3 offset:256
    ds_read_b128 v[36:39], v3 offset:320
    ds_read_b128 v[40:43], v3 offset:384
    ds_read_b128 v[44:47], v3 offset:448
    ds_read_b128 v[48:51], v3 offset:512
    ds_read_b128 v[52:55], v3 offset:576
    ds_read_b128 v[56:59], v3 offset:640
    ds_read_b128 v[60:63], v3 offset:704
    ds_read_b128 v[64:67], v3 offset:768
    ds_read_b128 v[68:71], v3 offset:832
    ds_read_b128 v[72:75], v3 offset:14592
    ds_read_b128 v[76:79], v3 offset:14656
    ds_read_b128 v[80:83], v3 offset:14720
    ds_read_b128 v[84:87], v3 offset:14784
    ds_read_b128 v[88:91], v3 offset:14848
    ds_read_b128 v[92:95], v3 offset:14912
    ds_read_b128 v[96:99], v3 offset:14976
    ds_read_b128 v[100:103], v3 offset:15040
    ds_read_b128 v[104:107], v3 offset:15104
    ds_read_b128 v[108:111], v3 offset:15168
    ds_read_b128 v[112:115], v3 offset:15232
    ds_read_b128 v[116:119], v3 offset:15296
    ds_read_b128 v[120:123], v3 offset:15360
    ds_read_b128 v[124:127], v3 offset:15424
    s_waitcnt lgkmcnt(0)
    s_barrier
    s_add_u32 s30, s39, 0
    s_mov_b32 m0, s30
    s_add_u32 s31, s38, 229376
    buffer_load_dwordx4 v2, s[60:63], s31 offen lds
    s_add_u32 s30, s39, 1024
    s_mov_b32 m0, s30
    s_add_u32 s31, s38, 243712
    buffer_load_dwordx4 v2, s[60:63], s31 offen lds
    s_add_u32 s30, s39, 16384
    s_mov_b32 m0, s30
    s_add_u32 s31, s38, 344064
    buffer_load_dwordx4 v2, s[60:63], s31 offen lds
    s_add_u32 s30, s39, 17408
    s_mov_b32 m0, s30
    s_add_u32 s31, s38, 358400
    buffer_load_dwordx4 v2, s[60:63], s31 offen lds
    s_add_u32 s30, s39, 32768
    s_mov_b32 m0, s30
    s_add_u32 s31, s38, 458752
    buffer_load_dwordx4 v2, s[60:63], s31 offen lds
    s_add_u32 s30, s39, 33792
    s_mov_b32 m0, s30
    s_add_u32 s31, s38, 473088
    buffer_load_dwordx4 v2, s[60:63], s31 offen lds
    s_add_u32 s30, s39, 49152
    s_mov_b32 m0, s30
    s_add_u32 s31, s38, 573440
    buffer_load_dwordx4 v2, s[60:63], s31 offen lds
    s_add_u32 s30, s39, 50176
    s_mov_b32 m0, s30
    s_add_u32 s31, s38, 587776
    buffer_load_dwordx4 v2, s[60:63], s31 offen lds
    s_add_u32 s30, s39, 65536
    s_mov_b32 m0, s30
    s_add_u32 s31, s38, 688128
    buffer_load_dwordx4 v2, s[60:63], s31 offen lds
    s_add_u32 s30, s39, 66560
    s_mov_b32 m0, s30
    s_add_u32 s31, s38, 702464
    buffer_load_dwordx4 v2, s[60:63], s31 offen lds
    s_add_u32 s30, s39, 81920
    s_mov_b32 m0, s30
    s_add_u32 s31, s38, 802816
    buffer_load_dwordx4 v2, s[60:63], s31 offen lds
    s_add_u32 s30, s39, 82944
    s_mov_b32 m0, s30
    s_add_u32 s31, s38, 817152
    buffer_load_dwordx4 v2, s[60:63], s31 offen lds
    s_add_u32 s30, s39, 98304
    s_mov_b32 m0, s30
    s_add_u32 s31, s38, 917504
    buffer_load_dwordx4 v2, s[60:63], s31 offen lds
    s_add_u32 s30, s39, 99328
    s_mov_b32 m0, s30
    s_add_u32 s31, s38, 931840
    buffer_load_dwordx4 v2, s[60:63], s31 offen lds
    s_add_u32 s30, s39, 114688
    s_mov_b32 m0, s30
    s_add_u32 s31, s38, 1032192
    buffer_load_dwordx4 v2, s[60:63], s31 offen lds
    s_add_u32 s30, s39, 115712
    s_mov_b32 m0, s30
    s_add_u32 s31, s38, 1046528
    buffer_load_dwordx4 v2, s[60:63], s31 offen lds
    s_waitcnt vmcnt(16)
    s_barrier
    ds_read_b64_tr_b16 v[128:129], v152 offset:0
    ds_read_b64_tr_b16 v[130:131], v152 offset:1024
    ds_read_b64_tr_b16 v[132:133], v152 offset:8192
    ds_read_b64_tr_b16 v[134:135], v152 offset:9216
    ds_read_b64_tr_b16 v[136:137], v153 offset:0
    ds_read_b64_tr_b16 v[138:139], v153 offset:1024
    s_waitcnt lgkmcnt(4)
    v_mfma_f32_16x16x32_bf16 a[0:3], v[128:131], v[16:19], a[0:3]
    v_mfma_f32_16x16x32_bf16 a[32:35], v[128:131], v[72:75], a[32:35]
    ds_read_b64_tr_b16 v[140:141], v153 offset:8192
    ds_read_b64_tr_b16 v[142:143], v153 offset:9216
    s_waitcnt lgkmcnt(4)
    v_mfma_f32_16x16x32_bf16 a[4:7], v[132:135], v[16:19], a[4:7]
    v_mfma_f32_16x16x32_bf16 a[36:39], v[132:135], v[72:75], a[36:39]
    ds_read_b64_tr_b16 v[128:129], v154 offset:0
    ds_read_b64_tr_b16 v[130:131], v154 offset:1024
    s_waitcnt lgkmcnt(4)
    v_mfma_f32_16x16x32_bf16 a[8:11], v[136:139], v[16:19], a[8:11]
    v_mfma_f32_16x16x32_bf16 a[40:43], v[136:139], v[72:75], a[40:43]
    ds_read_b64_tr_b16 v[132:133], v154 offset:8192
    ds_read_b64_tr_b16 v[134:135], v154 offset:9216
    s_waitcnt lgkmcnt(4)
    v_mfma_f32_16x16x32_bf16 a[12:15], v[140:143], v[16:19], a[12:15]
    v_mfma_f32_16x16x32_bf16 a[44:47], v[140:143], v[72:75], a[44:47]
    ds_read_b64_tr_b16 v[136:137], v155 offset:0
    ds_read_b64_tr_b16 v[138:139], v155 offset:1024
    s_waitcnt lgkmcnt(4)
    v_mfma_f32_16x16x32_bf16 a[16:19], v[128:131], v[16:19], a[16:19]
    v_mfma_f32_16x16x32_bf16 a[48:51], v[128:131], v[72:75], a[48:51]
    ds_read_b64_tr_b16 v[140:141], v155 offset:8192
    ds_read_b64_tr_b16 v[142:143], v155 offset:9216
    s_waitcnt lgkmcnt(4)
    v_mfma_f32_16x16x32_bf16 a[20:23], v[132:135], v[16:19], a[20:23]
    v_mfma_f32_16x16x32_bf16 a[52:55], v[132:135], v[72:75], a[52:55]
    ds_read_b64_tr_b16 v[128:129], v152 offset:16384
    ds_read_b64_tr_b16 v[130:131], v152 offset:17408
    s_waitcnt lgkmcnt(4)
    v_mfma_f32_16x16x32_bf16 a[24:27], v[136:139], v[16:19], a[24:27]
    v_mfma_f32_16x16x32_bf16 a[56:59], v[136:139], v[72:75], a[56:59]
    ds_read_b64_tr_b16 v[132:133], v152 offset:24576
    ds_read_b64_tr_b16 v[134:135], v152 offset:25600
    s_waitcnt lgkmcnt(4)
    v_mfma_f32_16x16x32_bf16 a[28:31], v[140:143], v[16:19], a[28:31]
    v_mfma_f32_16x16x32_bf16 a[60:63], v[140:143], v[72:75], a[60:63]
    ds_read_b64_tr_b16 v[136:137], v153 offset:16384
    ds_read_b64_tr_b16 v[138:139], v153 offset:17408
    s_waitcnt lgkmcnt(4)
    v_mfma_f32_16x16x32_bf16 a[0:3], v[128:131], v[20:23], a[0:3]
    v_mfma_f32_16x16x32_bf16 a[32:35], v[128:131], v[76:79], a[32:35]
    ds_read_b64_tr_b16 v[140:141], v153 offset:24576
    ds_read_b64_tr_b16 v[142:143], v153 offset:25600
    s_waitcnt lgkmcnt(4)
    v_mfma_f32_16x16x32_bf16 a[4:7], v[132:135], v[20:23], a[4:7]
    v_mfma_f32_16x16x32_bf16 a[36:39], v[132:135], v[76:79], a[36:39]
    ds_read_b64_tr_b16 v[128:129], v154 offset:16384
    ds_read_b64_tr_b16 v[130:131], v154 offset:17408
    s_waitcnt lgkmcnt(4)
    v_mfma_f32_16x16x32_bf16 a[8:11], v[136:139], v[20:23], a[8:11]
    v_mfma_f32_16x16x32_bf16 a[40:43], v[136:139], v[76:79], a[40:43]
    ds_read_b64_tr_b16 v[132:133], v154 offset:24576
    ds_read_b64_tr_b16 v[134:135], v154 offset:25600
    s_waitcnt lgkmcnt(4)
    v_mfma_f32_16x16x32_bf16 a[12:15], v[140:143], v[20:23], a[12:15]
    v_mfma_f32_16x16x32_bf16 a[44:47], v[140:143], v[76:79], a[44:47]
    ds_read_b64_tr_b16 v[136:137], v155 offset:16384
    ds_read_b64_tr_b16 v[138:139], v155 offset:17408
    s_waitcnt lgkmcnt(4)
    v_mfma_f32_16x16x32_bf16 a[16:19], v[128:131], v[20:23], a[16:19]
    v_mfma_f32_16x16x32_bf16 a[48:51], v[128:131], v[76:79], a[48:51]
    ds_read_b64_tr_b16 v[140:141], v155 offset:24576
    ds_read_b64_tr_b16 v[142:143], v155 offset:25600
    s_waitcnt lgkmcnt(4)
    v_mfma_f32_16x16x32_bf16 a[20:23], v[132:135], v[20:23], a[20:23]
    v_mfma_f32_16x16x32_bf16 a[52:55], v[132:135], v[76:79], a[52:55]
    s_waitcnt lgkmcnt(2)
    v_mfma_f32_16x16x32_bf16 a[24:27], v[136:139], v[20:23], a[24:27]
    v_mfma_f32_16x16x32_bf16 a[56:59], v[136:139], v[76:79], a[56:59]
    s_waitcnt lgkmcnt(0)
    v_mfma_f32_16x16x32_bf16 a[28:31], v[140:143], v[20:23], a[28:31]
    v_mfma_f32_16x16x32_bf16 a[60:63], v[140:143], v[76:79], a[60:63]
    s_waitcnt vmcnt(8)
    s_barrier
    ds_read_b64_tr_b16 v[128:129], v144 offset:0
    ds_read_b64_tr_b16 v[130:131], v144 offset:1024
    ds_read_b64_tr_b16 v[132:133], v144 offset:8192
    ds_read_b64_tr_b16 v[134:135], v144 offset:9216
    ds_read_b64_tr_b16 v[136:137], v145 offset:0
    ds_read_b64_tr_b16 v[138:139], v145 offset:1024
    s_waitcnt lgkmcnt(4)
    v_mfma_f32_16x16x32_bf16 a[0:3], v[128:131], v[24:27], a[0:3]
    v_mfma_f32_16x16x32_bf16 a[32:35], v[128:131], v[80:83], a[32:35]
    ds_read_b64_tr_b16 v[140:141], v145 offset:8192
    ds_read_b64_tr_b16 v[142:143], v145 offset:9216
    s_waitcnt lgkmcnt(4)
    v_mfma_f32_16x16x32_bf16 a[4:7], v[132:135], v[24:27], a[4:7]
    v_mfma_f32_16x16x32_bf16 a[36:39], v[132:135], v[80:83], a[36:39]
    ds_read_b64_tr_b16 v[128:129], v146 offset:0
    ds_read_b64_tr_b16 v[130:131], v146 offset:1024
    s_waitcnt lgkmcnt(4)
    v_mfma_f32_16x16x32_bf16 a[8:11], v[136:139], v[24:27], a[8:11]
    v_mfma_f32_16x16x32_bf16 a[40:43], v[136:139], v[80:83], a[40:43]
    ds_read_b64_tr_b16 v[132:133], v146 offset:8192
    ds_read_b64_tr_b16 v[134:135], v146 offset:9216
    s_waitcnt lgkmcnt(4)
    v_mfma_f32_16x16x32_bf16 a[12:15], v[140:143], v[24:27], a[12:15]
    v_mfma_f32_16x16x32_bf16 a[44:47], v[140:143], v[80:83], a[44:47]
    ds_read_b64_tr_b16 v[136:137], v147 offset:0
    ds_read_b64_tr_b16 v[138:139], v147 offset:1024
    s_waitcnt lgkmcnt(4)
    v_mfma_f32_16x16x32_bf16 a[16:19], v[128:131], v[24:27], a[16:19]
    v_mfma_f32_16x16x32_bf16 a[48:51], v[128:131], v[80:83], a[48:51]
    ds_read_b64_tr_b16 v[140:141], v147 offset:8192
    ds_read_b64_tr_b16 v[142:143], v147 offset:9216
    s_waitcnt lgkmcnt(4)
    v_mfma_f32_16x16x32_bf16 a[20:23], v[132:135], v[24:27], a[20:23]
    v_mfma_f32_16x16x32_bf16 a[52:55], v[132:135], v[80:83], a[52:55]
    ds_read_b64_tr_b16 v[128:129], v144 offset:16384
    ds_read_b64_tr_b16 v[130:131], v144 offset:17408
    s_waitcnt lgkmcnt(4)
    v_mfma_f32_16x16x32_bf16 a[24:27], v[136:139], v[24:27], a[24:27]
    v_mfma_f32_16x16x32_bf16 a[56:59], v[136:139], v[80:83], a[56:59]
    ds_read_b64_tr_b16 v[132:133], v144 offset:24576
    ds_read_b64_tr_b16 v[134:135], v144 offset:25600
    s_waitcnt lgkmcnt(4)
    v_mfma_f32_16x16x32_bf16 a[28:31], v[140:143], v[24:27], a[28:31]
    v_mfma_f32_16x16x32_bf16 a[60:63], v[140:143], v[80:83], a[60:63]
    ds_read_b64_tr_b16 v[136:137], v145 offset:16384
    ds_read_b64_tr_b16 v[138:139], v145 offset:17408
    s_waitcnt lgkmcnt(4)
    v_mfma_f32_16x16x32_bf16 a[0:3], v[128:131], v[28:31], a[0:3]
    v_mfma_f32_16x16x32_bf16 a[32:35], v[128:131], v[84:87], a[32:35]
    ds_read_b64_tr_b16 v[140:141], v145 offset:24576
    ds_read_b64_tr_b16 v[142:143], v145 offset:25600
    s_waitcnt lgkmcnt(4)
    v_mfma_f32_16x16x32_bf16 a[4:7], v[132:135], v[28:31], a[4:7]
    v_mfma_f32_16x16x32_bf16 a[36:39], v[132:135], v[84:87], a[36:39]
    ds_read_b64_tr_b16 v[128:129], v146 offset:16384
    ds_read_b64_tr_b16 v[130:131], v146 offset:17408
    s_waitcnt lgkmcnt(4)
    v_mfma_f32_16x16x32_bf16 a[8:11], v[136:139], v[28:31], a[8:11]
    v_mfma_f32_16x16x32_bf16 a[40:43], v[136:139], v[84:87], a[40:43]
    ds_read_b64_tr_b16 v[132:133], v146 offset:24576
    ds_read_b64_tr_b16 v[134:135], v146 offset:25600
    s_waitcnt lgkmcnt(4)
    v_mfma_f32_16x16x32_bf16 a[12:15], v[140:143], v[28:31], a[12:15]
    v_mfma_f32_16x16x32_bf16 a[44:47], v[140:143], v[84:87], a[44:47]
    ds_read_b64_tr_b16 v[136:137], v147 offset:16384
    ds_read_b64_tr_b16 v[138:139], v147 offset:17408
    s_waitcnt lgkmcnt(4)
    v_mfma_f32_16x16x32_bf16 a[16:19], v[128:131], v[28:31], a[16:19]
    v_mfma_f32_16x16x32_bf16 a[48:51], v[128:131], v[84:87], a[48:51]
    ds_read_b64_tr_b16 v[140:141], v147 offset:24576
    ds_read_b64_tr_b16 v[142:143], v147 offset:25600
    s_waitcnt lgkmcnt(4)
    v_mfma_f32_16x16x32_bf16 a[20:23], v[132:135], v[28:31], a[20:23]
    v_mfma_f32_16x16x32_bf16 a[52:55], v[132:135], v[84:87], a[52:55]
    ds_read_b64_tr_b16 v[128:129], v144 offset:32768
    ds_read_b64_tr_b16 v[130:131], v144 offset:33792
    s_waitcnt lgkmcnt(4)
    v_mfma_f32_16x16x32_bf16 a[24:27], v[136:139], v[28:31], a[24:27]
    v_mfma_f32_16x16x32_bf16 a[56:59], v[136:139], v[84:87], a[56:59]
    ds_read_b64_tr_b16 v[132:133], v144 offset:40960
    ds_read_b64_tr_b16 v[134:135], v144 offset:41984
    s_waitcnt lgkmcnt(4)
    v_mfma_f32_16x16x32_bf16 a[28:31], v[140:143], v[28:31], a[28:31]
    v_mfma_f32_16x16x32_bf16 a[60:63], v[140:143], v[84:87], a[60:63]
    ds_read_b64_tr_b16 v[136:137], v145 offset:32768
    ds_read_b64_tr_b16 v[138:139], v145 offset:33792
    s_waitcnt lgkmcnt(4)
    v_mfma_f32_16x16x32_bf16 a[0:3], v[128:131], v[32:35], a[0:3]
    v_mfma_f32_16x16x32_bf16 a[32:35], v[128:131], v[88:91], a[32:35]
    ds_read_b64_tr_b16 v[140:141], v145 offset:40960
    ds_read_b64_tr_b16 v[142:143], v145 offset:41984
    s_waitcnt lgkmcnt(4)
    v_mfma_f32_16x16x32_bf16 a[4:7], v[132:135], v[32:35], a[4:7]
    v_mfma_f32_16x16x32_bf16 a[36:39], v[132:135], v[88:91], a[36:39]
    ds_read_b64_tr_b16 v[128:129], v146 offset:32768
    ds_read_b64_tr_b16 v[130:131], v146 offset:33792
    s_waitcnt lgkmcnt(4)
    v_mfma_f32_16x16x32_bf16 a[8:11], v[136:139], v[32:35], a[8:11]
    v_mfma_f32_16x16x32_bf16 a[40:43], v[136:139], v[88:91], a[40:43]
    ds_read_b64_tr_b16 v[132:133], v146 offset:40960
    ds_read_b64_tr_b16 v[134:135], v146 offset:41984
    s_waitcnt lgkmcnt(4)
    v_mfma_f32_16x16x32_bf16 a[12:15], v[140:143], v[32:35], a[12:15]
    v_mfma_f32_16x16x32_bf16 a[44:47], v[140:143], v[88:91], a[44:47]
    ds_read_b64_tr_b16 v[136:137], v147 offset:32768
    ds_read_b64_tr_b16 v[138:139], v147 offset:33792
    s_waitcnt lgkmcnt(4)
    v_mfma_f32_16x16x32_bf16 a[16:19], v[128:131], v[32:35], a[16:19]
    v_mfma_f32_16x16x32_bf16 a[48:51], v[128:131], v[88:91], a[48:51]
    ds_read_b64_tr_b16 v[140:141], v147 offset:40960
    ds_read_b64_tr_b16 v[142:143], v147 offset:41984
    s_waitcnt lgkmcnt(4)
    v_mfma_f32_16x16x32_bf16 a[20:23], v[132:135], v[32:35], a[20:23]
    v_mfma_f32_16x16x32_bf16 a[52:55], v[132:135], v[88:91], a[52:55]
    ds_read_b64_tr_b16 v[128:129], v144 offset:49152
    ds_read_b64_tr_b16 v[130:131], v144 offset:50176
    s_waitcnt lgkmcnt(4)
    v_mfma_f32_16x16x32_bf16 a[24:27], v[136:139], v[32:35], a[24:27]
    v_mfma_f32_16x16x32_bf16 a[56:59], v[136:139], v[88:91], a[56:59]
    ds_read_b64_tr_b16 v[132:133], v144 offset:57344
    ds_read_b64_tr_b16 v[134:135], v144 offset:58368
    s_waitcnt lgkmcnt(4)
    v_mfma_f32_16x16x32_bf16 a[28:31], v[140:143], v[32:35], a[28:31]
    v_mfma_f32_16x16x32_bf16 a[60:63], v[140:143], v[88:91], a[60:63]
    ds_read_b64_tr_b16 v[136:137], v145 offset:49152
    ds_read_b64_tr_b16 v[138:139], v145 offset:50176
    s_waitcnt lgkmcnt(4)
    v_mfma_f32_16x16x32_bf16 a[0:3], v[128:131], v[36:39], a[0:3]
    v_mfma_f32_16x16x32_bf16 a[32:35], v[128:131], v[92:95], a[32:35]
    ds_read_b64_tr_b16 v[140:141], v145 offset:57344
    ds_read_b64_tr_b16 v[142:143], v145 offset:58368
    s_waitcnt lgkmcnt(4)
    v_mfma_f32_16x16x32_bf16 a[4:7], v[132:135], v[36:39], a[4:7]
    v_mfma_f32_16x16x32_bf16 a[36:39], v[132:135], v[92:95], a[36:39]
    ds_read_b64_tr_b16 v[128:129], v146 offset:49152
    ds_read_b64_tr_b16 v[130:131], v146 offset:50176
    s_waitcnt lgkmcnt(4)
    v_mfma_f32_16x16x32_bf16 a[8:11], v[136:139], v[36:39], a[8:11]
    v_mfma_f32_16x16x32_bf16 a[40:43], v[136:139], v[92:95], a[40:43]
    ds_read_b64_tr_b16 v[132:133], v146 offset:57344
    ds_read_b64_tr_b16 v[134:135], v146 offset:58368
    s_waitcnt lgkmcnt(4)
    v_mfma_f32_16x16x32_bf16 a[12:15], v[140:143], v[36:39], a[12:15]
    v_mfma_f32_16x16x32_bf16 a[44:47], v[140:143], v[92:95], a[44:47]
    ds_read_b64_tr_b16 v[136:137], v147 offset:49152
    ds_read_b64_tr_b16 v[138:139], v147 offset:50176
    s_waitcnt lgkmcnt(4)
    v_mfma_f32_16x16x32_bf16 a[16:19], v[128:131], v[36:39], a[16:19]
    v_mfma_f32_16x16x32_bf16 a[48:51], v[128:131], v[92:95], a[48:51]
    ds_read_b64_tr_b16 v[140:141], v147 offset:57344
    ds_read_b64_tr_b16 v[142:143], v147 offset:58368
    s_waitcnt lgkmcnt(4)
    v_mfma_f32_16x16x32_bf16 a[20:23], v[132:135], v[36:39], a[20:23]
    v_mfma_f32_16x16x32_bf16 a[52:55], v[132:135], v[92:95], a[52:55]
    s_waitcnt lgkmcnt(2)
    v_mfma_f32_16x16x32_bf16 a[24:27], v[136:139], v[36:39], a[24:27]
    v_mfma_f32_16x16x32_bf16 a[56:59], v[136:139], v[92:95], a[56:59]
    s_waitcnt lgkmcnt(0)
    v_mfma_f32_16x16x32_bf16 a[28:31], v[140:143], v[36:39], a[28:31]
    v_mfma_f32_16x16x32_bf16 a[60:63], v[140:143], v[92:95], a[60:63]
    s_waitcnt vmcnt(0)
    s_barrier
    s_add_u32 s30, s39, 131072
    s_mov_b32 m0, s30
    s_add_u32 s31, s38, 1146880
    buffer_load_dwordx4 v2, s[60:63], s31 offen lds
    s_add_u32 s30, s39, 132096
    s_mov_b32 m0, s30
    s_add_u32 s31, s38, 1161216
    buffer_load_dwordx4 v2, s[60:63], s31 offen lds
    s_add_u32 s30, s39, 147456
    s_mov_b32 m0, s30
    s_add_u32 s31, s38, 1261568
    buffer_load_dwordx4 v2, s[60:63], s31 offen lds
    s_add_u32 s30, s39, 148480
    s_mov_b32 m0, s30
    s_add_u32 s31, s38, 1275904
    buffer_load_dwordx4 v2, s[60:63], s31 offen lds
    s_add_u32 s30, s39, 0
    s_mov_b32 m0, s30
    s_add_u32 s31, s38, 1376256
    buffer_load_dwordx4 v2, s[60:63], s31 offen lds
    s_add_u32 s30, s39, 1024
    s_mov_b32 m0, s30
    s_add_u32 s31, s38, 1390592
    buffer_load_dwordx4 v2, s[60:63], s31 offen lds
    s_add_u32 s30, s39, 16384
    s_mov_b32 m0, s30
    s_add_u32 s31, s38, 1490944
    buffer_load_dwordx4 v2, s[60:63], s31 offen lds
    s_add_u32 s30, s39, 17408
    s_mov_b32 m0, s30
    s_add_u32 s31, s38, 1505280
    buffer_load_dwordx4 v2, s[60:63], s31 offen lds
    ds_read_b64_tr_b16 v[128:129], v148 offset:0
    ds_read_b64_tr_b16 v[130:131], v148 offset:1024
    ds_read_b64_tr_b16 v[132:133], v148 offset:8192
    ds_read_b64_tr_b16 v[134:135], v148 offset:9216
    ds_read_b64_tr_b16 v[136:137], v149 offset:0
    ds_read_b64_tr_b16 v[138:139], v149 offset:1024
    s_waitcnt lgkmcnt(4)
    v_mfma_f32_16x16x32_bf16 a[0:3], v[128:131], v[40:43], a[0:3]
    v_mfma_f32_16x16x32_bf16 a[32:35], v[128:131], v[96:99], a[32:35]
    ds_read_b64_tr_b16 v[140:141], v149 offset:8192
    ds_read_b64_tr_b16 v[142:143], v149 offset:9216
    s_waitcnt lgkmcnt(4)
    v_mfma_f32_16x16x32_bf16 a[4:7], v[132:135], v[40:43], a[4:7]
    v_mfma_f32_16x16x32_bf16 a[36:39], v[132:135], v[96:99], a[36:39]
    ds_read_b64_tr_b16 v[128:129], v150 offset:0
    ds_read_b64_tr_b16 v[130:131], v150 offset:1024
    s_waitcnt lgkmcnt(4)
    v_mfma_f32_16x16x32_bf16 a[8:11], v[136:139], v[40:43], a[8:11]
    v_mfma_f32_16x16x32_bf16 a[40:43], v[136:139], v[96:99], a[40:43]
    ds_read_b64_tr_b16 v[132:133], v150 offset:8192
    ds_read_b64_tr_b16 v[134:135], v150 offset:9216
    s_waitcnt lgkmcnt(4)
    v_mfma_f32_16x16x32_bf16 a[12:15], v[140:143], v[40:43], a[12:15]
    v_mfma_f32_16x16x32_bf16 a[44:47], v[140:143], v[96:99], a[44:47]
    ds_read_b64_tr_b16 v[136:137], v151 offset:0
    ds_read_b64_tr_b16 v[138:139], v151 offset:1024
    s_waitcnt lgkmcnt(4)
    v_mfma_f32_16x16x32_bf16 a[16:19], v[128:131], v[40:43], a[16:19]
    v_mfma_f32_16x16x32_bf16 a[48:51], v[128:131], v[96:99], a[48:51]
    ds_read_b64_tr_b16 v[140:141], v151 offset:8192
    ds_read_b64_tr_b16 v[142:143], v151 offset:9216
    s_waitcnt lgkmcnt(4)
    v_mfma_f32_16x16x32_bf16 a[20:23], v[132:135], v[40:43], a[20:23]
    v_mfma_f32_16x16x32_bf16 a[52:55], v[132:135], v[96:99], a[52:55]
    ds_read_b64_tr_b16 v[128:129], v148 offset:16384
    ds_read_b64_tr_b16 v[130:131], v148 offset:17408
    s_waitcnt lgkmcnt(4)
    v_mfma_f32_16x16x32_bf16 a[24:27], v[136:139], v[40:43], a[24:27]
    v_mfma_f32_16x16x32_bf16 a[56:59], v[136:139], v[96:99], a[56:59]
    ds_read_b64_tr_b16 v[132:133], v148 offset:24576
    ds_read_b64_tr_b16 v[134:135], v148 offset:25600
    s_waitcnt lgkmcnt(4)
    v_mfma_f32_16x16x32_bf16 a[28:31], v[140:143], v[40:43], a[28:31]
    v_mfma_f32_16x16x32_bf16 a[60:63], v[140:143], v[96:99], a[60:63]
    ds_read_b64_tr_b16 v[136:137], v149 offset:16384
    ds_read_b64_tr_b16 v[138:139], v149 offset:17408
    s_waitcnt lgkmcnt(4)
    v_mfma_f32_16x16x32_bf16 a[0:3], v[128:131], v[44:47], a[0:3]
    v_mfma_f32_16x16x32_bf16 a[32:35], v[128:131], v[100:103], a[32:35]
    ds_read_b64_tr_b16 v[140:141], v149 offset:24576
    ds_read_b64_tr_b16 v[142:143], v149 offset:25600
    s_waitcnt lgkmcnt(4)
    v_mfma_f32_16x16x32_bf16 a[4:7], v[132:135], v[44:47], a[4:7]
    v_mfma_f32_16x16x32_bf16 a[36:39], v[132:135], v[100:103], a[36:39]
    ds_read_b64_tr_b16 v[128:129], v150 offset:16384
    ds_read_b64_tr_b16 v[130:131], v150 offset:17408
    s_waitcnt lgkmcnt(4)
    v_mfma_f32_16x16x32_bf16 a[8:11], v[136:139], v[44:47], a[8:11]
    v_mfma_f32_16x16x32_bf16 a[40:43], v[136:139], v[100:103], a[40:43]
    ds_read_b64_tr_b16 v[132:133], v150 offset:24576
    ds_read_b64_tr_b16 v[134:135], v150 offset:25600
    s_waitcnt lgkmcnt(4)
    v_mfma_f32_16x16x32_bf16 a[12:15], v[140:143], v[44:47], a[12:15]
    v_mfma_f32_16x16x32_bf16 a[44:47], v[140:143], v[100:103], a[44:47]
    ds_read_b64_tr_b16 v[136:137], v151 offset:16384
    ds_read_b64_tr_b16 v[138:139], v151 offset:17408
    s_waitcnt lgkmcnt(4)
    v_mfma_f32_16x16x32_bf16 a[16:19], v[128:131], v[44:47], a[16:19]
    v_mfma_f32_16x16x32_bf16 a[48:51], v[128:131], v[100:103], a[48:51]
    ds_read_b64_tr_b16 v[140:141], v151 offset:24576
    ds_read_b64_tr_b16 v[142:143], v151 offset:25600
    s_waitcnt lgkmcnt(4)
    v_mfma_f32_16x16x32_bf16 a[20:23], v[132:135], v[44:47], a[20:23]
    v_mfma_f32_16x16x32_bf16 a[52:55], v[132:135], v[100:103], a[52:55]
    ds_read_b64_tr_b16 v[128:129], v148 offset:32768
    ds_read_b64_tr_b16 v[130:131], v148 offset:33792
    s_waitcnt lgkmcnt(4)
    v_mfma_f32_16x16x32_bf16 a[24:27], v[136:139], v[44:47], a[24:27]
    v_mfma_f32_16x16x32_bf16 a[56:59], v[136:139], v[100:103], a[56:59]
    ds_read_b64_tr_b16 v[132:133], v148 offset:40960
    ds_read_b64_tr_b16 v[134:135], v148 offset:41984
    s_waitcnt lgkmcnt(4)
    v_mfma_f32_16x16x32_bf16 a[28:31], v[140:143], v[44:47], a[28:31]
    v_mfma_f32_16x16x32_bf16 a[60:63], v[140:143], v[100:103], a[60:63]
    ds_read_b64_tr_b16 v[136:137], v149 offset:32768
    ds_read_b64_tr_b16 v[138:139], v149 offset:33792
    s_waitcnt lgkmcnt(4)
    v_mfma_f32_16x16x32_bf16 a[0:3], v[128:131], v[48:51], a[0:3]
    v_mfma_f32_16x16x32_bf16 a[32:35], v[128:131], v[104:107], a[32:35]
    ds_read_b64_tr_b16 v[140:141], v149 offset:40960
    ds_read_b64_tr_b16 v[142:143], v149 offset:41984
    s_waitcnt lgkmcnt(4)
    v_mfma_f32_16x16x32_bf16 a[4:7], v[132:135], v[48:51], a[4:7]
    v_mfma_f32_16x16x32_bf16 a[36:39], v[132:135], v[104:107], a[36:39]
    ds_read_b64_tr_b16 v[128:129], v150 offset:32768
    ds_read_b64_tr_b16 v[130:131], v150 offset:33792
    s_waitcnt lgkmcnt(4)
    v_mfma_f32_16x16x32_bf16 a[8:11], v[136:139], v[48:51], a[8:11]
    v_mfma_f32_16x16x32_bf16 a[40:43], v[136:139], v[104:107], a[40:43]
    ds_read_b64_tr_b16 v[132:133], v150 offset:40960
    ds_read_b64_tr_b16 v[134:135], v150 offset:41984
    s_waitcnt lgkmcnt(4)
    v_mfma_f32_16x16x32_bf16 a[12:15], v[140:143], v[48:51], a[12:15]
    v_mfma_f32_16x16x32_bf16 a[44:47], v[140:143], v[104:107], a[44:47]
    ds_read_b64_tr_b16 v[136:137], v151 offset:32768
    ds_read_b64_tr_b16 v[138:139], v151 offset:33792
    s_waitcnt lgkmcnt(4)
    v_mfma_f32_16x16x32_bf16 a[16:19], v[128:131], v[48:51], a[16:19]
    v_mfma_f32_16x16x32_bf16 a[48:51], v[128:131], v[104:107], a[48:51]
    ds_read_b64_tr_b16 v[140:141], v151 offset:40960
    ds_read_b64_tr_b16 v[142:143], v151 offset:41984
    s_waitcnt lgkmcnt(4)
    v_mfma_f32_16x16x32_bf16 a[20:23], v[132:135], v[48:51], a[20:23]
    v_mfma_f32_16x16x32_bf16 a[52:55], v[132:135], v[104:107], a[52:55]
    ds_read_b64_tr_b16 v[128:129], v148 offset:49152
    ds_read_b64_tr_b16 v[130:131], v148 offset:50176
    s_waitcnt lgkmcnt(4)
    v_mfma_f32_16x16x32_bf16 a[24:27], v[136:139], v[48:51], a[24:27]
    v_mfma_f32_16x16x32_bf16 a[56:59], v[136:139], v[104:107], a[56:59]
    ds_read_b64_tr_b16 v[132:133], v148 offset:57344
    ds_read_b64_tr_b16 v[134:135], v148 offset:58368
    s_waitcnt lgkmcnt(4)
    v_mfma_f32_16x16x32_bf16 a[28:31], v[140:143], v[48:51], a[28:31]
    v_mfma_f32_16x16x32_bf16 a[60:63], v[140:143], v[104:107], a[60:63]
    ds_read_b64_tr_b16 v[136:137], v149 offset:49152
    ds_read_b64_tr_b16 v[138:139], v149 offset:50176
    s_waitcnt lgkmcnt(4)
    v_mfma_f32_16x16x32_bf16 a[0:3], v[128:131], v[52:55], a[0:3]
    v_mfma_f32_16x16x32_bf16 a[32:35], v[128:131], v[108:111], a[32:35]
    ds_read_b64_tr_b16 v[140:141], v149 offset:57344
    ds_read_b64_tr_b16 v[142:143], v149 offset:58368
    s_waitcnt lgkmcnt(4)
    v_mfma_f32_16x16x32_bf16 a[4:7], v[132:135], v[52:55], a[4:7]
    v_mfma_f32_16x16x32_bf16 a[36:39], v[132:135], v[108:111], a[36:39]
    ds_read_b64_tr_b16 v[128:129], v150 offset:49152
    ds_read_b64_tr_b16 v[130:131], v150 offset:50176
    s_waitcnt lgkmcnt(4)
    v_mfma_f32_16x16x32_bf16 a[8:11], v[136:139], v[52:55], a[8:11]
    v_mfma_f32_16x16x32_bf16 a[40:43], v[136:139], v[108:111], a[40:43]
    ds_read_b64_tr_b16 v[132:133], v150 offset:57344
    ds_read_b64_tr_b16 v[134:135], v150 offset:58368
    s_waitcnt lgkmcnt(4)
    v_mfma_f32_16x16x32_bf16 a[12:15], v[140:143], v[52:55], a[12:15]
    v_mfma_f32_16x16x32_bf16 a[44:47], v[140:143], v[108:111], a[44:47]
    ds_read_b64_tr_b16 v[136:137], v151 offset:49152
    ds_read_b64_tr_b16 v[138:139], v151 offset:50176
    s_waitcnt lgkmcnt(4)
    v_mfma_f32_16x16x32_bf16 a[16:19], v[128:131], v[52:55], a[16:19]
    v_mfma_f32_16x16x32_bf16 a[48:51], v[128:131], v[108:111], a[48:51]
    ds_read_b64_tr_b16 v[140:141], v151 offset:57344
    ds_read_b64_tr_b16 v[142:143], v151 offset:58368
    s_waitcnt lgkmcnt(4)
    v_mfma_f32_16x16x32_bf16 a[20:23], v[132:135], v[52:55], a[20:23]
    v_mfma_f32_16x16x32_bf16 a[52:55], v[132:135], v[108:111], a[52:55]
    s_waitcnt lgkmcnt(2)
    v_mfma_f32_16x16x32_bf16 a[24:27], v[136:139], v[52:55], a[24:27]
    v_mfma_f32_16x16x32_bf16 a[56:59], v[136:139], v[108:111], a[56:59]
    s_waitcnt lgkmcnt(0)
    v_mfma_f32_16x16x32_bf16 a[28:31], v[140:143], v[52:55], a[28:31]
    v_mfma_f32_16x16x32_bf16 a[60:63], v[140:143], v[108:111], a[60:63]
    s_waitcnt vmcnt(0)
    s_barrier
    ds_read_b64_tr_b16 v[128:129], v152 offset:0
    ds_read_b64_tr_b16 v[130:131], v152 offset:1024
    ds_read_b64_tr_b16 v[132:133], v152 offset:8192
    ds_read_b64_tr_b16 v[134:135], v152 offset:9216
    ds_read_b64_tr_b16 v[136:137], v153 offset:0
    ds_read_b64_tr_b16 v[138:139], v153 offset:1024
    s_waitcnt lgkmcnt(4)
    v_mfma_f32_16x16x32_bf16 a[0:3], v[128:131], v[56:59], a[0:3]
    v_mfma_f32_16x16x32_bf16 a[32:35], v[128:131], v[112:115], a[32:35]
    ds_read_b64_tr_b16 v[140:141], v153 offset:8192
    ds_read_b64_tr_b16 v[142:143], v153 offset:9216
    s_waitcnt lgkmcnt(4)
    v_mfma_f32_16x16x32_bf16 a[4:7], v[132:135], v[56:59], a[4:7]
    v_mfma_f32_16x16x32_bf16 a[36:39], v[132:135], v[112:115], a[36:39]
    ds_read_b64_tr_b16 v[128:129], v154 offset:0
    ds_read_b64_tr_b16 v[130:131], v154 offset:1024
    s_waitcnt lgkmcnt(4)
    v_mfma_f32_16x16x32_bf16 a[8:11], v[136:139], v[56:59], a[8:11]
    v_mfma_f32_16x16x32_bf16 a[40:43], v[136:139], v[112:115], a[40:43]
    ds_read_b64_tr_b16 v[132:133], v154 offset:8192
    ds_read_b64_tr_b16 v[134:135], v154 offset:9216
    s_waitcnt lgkmcnt(4)
    v_mfma_f32_16x16x32_bf16 a[12:15], v[140:143], v[56:59], a[12:15]
    v_mfma_f32_16x16x32_bf16 a[44:47], v[140:143], v[112:115], a[44:47]
    ds_read_b64_tr_b16 v[136:137], v155 offset:0
    ds_read_b64_tr_b16 v[138:139], v155 offset:1024
    s_waitcnt lgkmcnt(4)
    v_mfma_f32_16x16x32_bf16 a[16:19], v[128:131], v[56:59], a[16:19]
    v_mfma_f32_16x16x32_bf16 a[48:51], v[128:131], v[112:115], a[48:51]
    ds_read_b64_tr_b16 v[140:141], v155 offset:8192
    ds_read_b64_tr_b16 v[142:143], v155 offset:9216
    s_waitcnt lgkmcnt(4)
    v_mfma_f32_16x16x32_bf16 a[20:23], v[132:135], v[56:59], a[20:23]
    v_mfma_f32_16x16x32_bf16 a[52:55], v[132:135], v[112:115], a[52:55]
    ds_read_b64_tr_b16 v[128:129], v152 offset:16384
    ds_read_b64_tr_b16 v[130:131], v152 offset:17408
    s_waitcnt lgkmcnt(4)
    v_mfma_f32_16x16x32_bf16 a[24:27], v[136:139], v[56:59], a[24:27]
    v_mfma_f32_16x16x32_bf16 a[56:59], v[136:139], v[112:115], a[56:59]
    ds_read_b64_tr_b16 v[132:133], v152 offset:24576
    ds_read_b64_tr_b16 v[134:135], v152 offset:25600
    s_waitcnt lgkmcnt(4)
    v_mfma_f32_16x16x32_bf16 a[28:31], v[140:143], v[56:59], a[28:31]
    v_mfma_f32_16x16x32_bf16 a[60:63], v[140:143], v[112:115], a[60:63]
    ds_read_b64_tr_b16 v[136:137], v153 offset:16384
    ds_read_b64_tr_b16 v[138:139], v153 offset:17408
    s_waitcnt lgkmcnt(4)
    v_mfma_f32_16x16x32_bf16 a[0:3], v[128:131], v[60:63], a[0:3]
    v_mfma_f32_16x16x32_bf16 a[32:35], v[128:131], v[116:119], a[32:35]
    ds_read_b64_tr_b16 v[140:141], v153 offset:24576
    ds_read_b64_tr_b16 v[142:143], v153 offset:25600
    s_waitcnt lgkmcnt(4)
    v_mfma_f32_16x16x32_bf16 a[4:7], v[132:135], v[60:63], a[4:7]
    v_mfma_f32_16x16x32_bf16 a[36:39], v[132:135], v[116:119], a[36:39]
    ds_read_b64_tr_b16 v[128:129], v154 offset:16384
    ds_read_b64_tr_b16 v[130:131], v154 offset:17408
    s_waitcnt lgkmcnt(4)
    v_mfma_f32_16x16x32_bf16 a[8:11], v[136:139], v[60:63], a[8:11]
    v_mfma_f32_16x16x32_bf16 a[40:43], v[136:139], v[116:119], a[40:43]
    ds_read_b64_tr_b16 v[132:133], v154 offset:24576
    ds_read_b64_tr_b16 v[134:135], v154 offset:25600
    s_waitcnt lgkmcnt(4)
    v_mfma_f32_16x16x32_bf16 a[12:15], v[140:143], v[60:63], a[12:15]
    v_mfma_f32_16x16x32_bf16 a[44:47], v[140:143], v[116:119], a[44:47]
    ds_read_b64_tr_b16 v[136:137], v155 offset:16384
    ds_read_b64_tr_b16 v[138:139], v155 offset:17408
    s_waitcnt lgkmcnt(4)
    v_mfma_f32_16x16x32_bf16 a[16:19], v[128:131], v[60:63], a[16:19]
    v_mfma_f32_16x16x32_bf16 a[48:51], v[128:131], v[116:119], a[48:51]
    ds_read_b64_tr_b16 v[140:141], v155 offset:24576
    ds_read_b64_tr_b16 v[142:143], v155 offset:25600
    s_waitcnt lgkmcnt(4)
    v_mfma_f32_16x16x32_bf16 a[20:23], v[132:135], v[60:63], a[20:23]
    v_mfma_f32_16x16x32_bf16 a[52:55], v[132:135], v[116:119], a[52:55]
    ds_read_b64_tr_b16 v[128:129], v144 offset:0
    ds_read_b64_tr_b16 v[130:131], v144 offset:1024
    s_waitcnt lgkmcnt(4)
    v_mfma_f32_16x16x32_bf16 a[24:27], v[136:139], v[60:63], a[24:27]
    v_mfma_f32_16x16x32_bf16 a[56:59], v[136:139], v[116:119], a[56:59]
    ds_read_b64_tr_b16 v[132:133], v144 offset:8192
    ds_read_b64_tr_b16 v[134:135], v144 offset:9216
    s_waitcnt lgkmcnt(4)
    v_mfma_f32_16x16x32_bf16 a[28:31], v[140:143], v[60:63], a[28:31]
    v_mfma_f32_16x16x32_bf16 a[60:63], v[140:143], v[116:119], a[60:63]
    ds_read_b64_tr_b16 v[136:137], v145 offset:0
    ds_read_b64_tr_b16 v[138:139], v145 offset:1024
    s_waitcnt lgkmcnt(4)
    v_mfma_f32_16x16x32_bf16 a[0:3], v[128:131], v[64:67], a[0:3]
    v_mfma_f32_16x16x32_bf16 a[32:35], v[128:131], v[120:123], a[32:35]
    ds_read_b64_tr_b16 v[140:141], v145 offset:8192
    ds_read_b64_tr_b16 v[142:143], v145 offset:9216
    s_waitcnt lgkmcnt(4)
    v_mfma_f32_16x16x32_bf16 a[4:7], v[132:135], v[64:67], a[4:7]
    v_mfma_f32_16x16x32_bf16 a[36:39], v[132:135], v[120:123], a[36:39]
    ds_read_b64_tr_b16 v[128:129], v146 offset:0
    ds_read_b64_tr_b16 v[130:131], v146 offset:1024
    s_waitcnt lgkmcnt(4)
    v_mfma_f32_16x16x32_bf16 a[8:11], v[136:139], v[64:67], a[8:11]
    v_mfma_f32_16x16x32_bf16 a[40:43], v[136:139], v[120:123], a[40:43]
    ds_read_b64_tr_b16 v[132:133], v146 offset:8192
    ds_read_b64_tr_b16 v[134:135], v146 offset:9216
    s_waitcnt lgkmcnt(4)
    v_mfma_f32_16x16x32_bf16 a[12:15], v[140:143], v[64:67], a[12:15]
    v_mfma_f32_16x16x32_bf16 a[44:47], v[140:143], v[120:123], a[44:47]
    ds_read_b64_tr_b16 v[136:137], v147 offset:0
    ds_read_b64_tr_b16 v[138:139], v147 offset:1024
    s_waitcnt lgkmcnt(4)
    v_mfma_f32_16x16x32_bf16 a[16:19], v[128:131], v[64:67], a[16:19]
    v_mfma_f32_16x16x32_bf16 a[48:51], v[128:131], v[120:123], a[48:51]
    ds_read_b64_tr_b16 v[140:141], v147 offset:8192
    ds_read_b64_tr_b16 v[142:143], v147 offset:9216
    s_waitcnt lgkmcnt(4)
    v_mfma_f32_16x16x32_bf16 a[20:23], v[132:135], v[64:67], a[20:23]
    v_mfma_f32_16x16x32_bf16 a[52:55], v[132:135], v[120:123], a[52:55]
    ds_read_b64_tr_b16 v[128:129], v144 offset:16384
    ds_read_b64_tr_b16 v[130:131], v144 offset:17408
    s_waitcnt lgkmcnt(4)
    v_mfma_f32_16x16x32_bf16 a[24:27], v[136:139], v[64:67], a[24:27]
    v_mfma_f32_16x16x32_bf16 a[56:59], v[136:139], v[120:123], a[56:59]
    ds_read_b64_tr_b16 v[132:133], v144 offset:24576
    ds_read_b64_tr_b16 v[134:135], v144 offset:25600
    s_waitcnt lgkmcnt(4)
    v_mfma_f32_16x16x32_bf16 a[28:31], v[140:143], v[64:67], a[28:31]
    v_mfma_f32_16x16x32_bf16 a[60:63], v[140:143], v[120:123], a[60:63]
    ds_read_b64_tr_b16 v[136:137], v145 offset:16384
    ds_read_b64_tr_b16 v[138:139], v145 offset:17408
    s_waitcnt lgkmcnt(4)
    v_mfma_f32_16x16x32_bf16 a[0:3], v[128:131], v[68:71], a[0:3]
    v_mfma_f32_16x16x32_bf16 a[32:35], v[128:131], v[124:127], a[32:35]
    ds_read_b64_tr_b16 v[140:141], v145 offset:24576
    ds_read_b64_tr_b16 v[142:143], v145 offset:25600
    s_waitcnt lgkmcnt(4)
    v_mfma_f32_16x16x32_bf16 a[4:7], v[132:135], v[68:71], a[4:7]
    v_mfma_f32_16x16x32_bf16 a[36:39], v[132:135], v[124:127], a[36:39]
    ds_read_b64_tr_b16 v[128:129], v146 offset:16384
    ds_read_b64_tr_b16 v[130:131], v146 offset:17408
    s_waitcnt lgkmcnt(4)
    v_mfma_f32_16x16x32_bf16 a[8:11], v[136:139], v[68:71], a[8:11]
    v_mfma_f32_16x16x32_bf16 a[40:43], v[136:139], v[124:127], a[40:43]
    ds_read_b64_tr_b16 v[132:133], v146 offset:24576
    ds_read_b64_tr_b16 v[134:135], v146 offset:25600
    s_waitcnt lgkmcnt(4)
    v_mfma_f32_16x16x32_bf16 a[12:15], v[140:143], v[68:71], a[12:15]
    v_mfma_f32_16x16x32_bf16 a[44:47], v[140:143], v[124:127], a[44:47]
    ds_read_b64_tr_b16 v[136:137], v147 offset:16384
    ds_read_b64_tr_b16 v[138:139], v147 offset:17408
    s_waitcnt lgkmcnt(4)
    v_mfma_f32_16x16x32_bf16 a[16:19], v[128:131], v[68:71], a[16:19]
    v_mfma_f32_16x16x32_bf16 a[48:51], v[128:131], v[124:127], a[48:51]
    ds_read_b64_tr_b16 v[140:141], v147 offset:24576
    ds_read_b64_tr_b16 v[142:143], v147 offset:25600
    s_waitcnt lgkmcnt(4)
    v_mfma_f32_16x16x32_bf16 a[20:23], v[132:135], v[68:71], a[20:23]
    v_mfma_f32_16x16x32_bf16 a[52:55], v[132:135], v[124:127], a[52:55]
    s_waitcnt lgkmcnt(2)
    v_mfma_f32_16x16x32_bf16 a[24:27], v[136:139], v[68:71], a[24:27]
    v_mfma_f32_16x16x32_bf16 a[56:59], v[136:139], v[124:127], a[56:59]
    s_waitcnt lgkmcnt(0)
    v_mfma_f32_16x16x32_bf16 a[28:31], v[140:143], v[68:71], a[28:31]
    v_mfma_f32_16x16x32_bf16 a[60:63], v[140:143], v[124:127], a[60:63]
    s_nop 8
    v_and_b32 v3, 15, v1
    v_add_u32 v3, s28, v3
    v_mul_u32_u24 v3, 3584, v3
    v_lshrrev_b32 v4, 4, v1
    v_lshl_add_u32 v3, v4, 3, v3
    v_add_u32 v4, 57344, v3
    s_lshl_b32 s30, s27, 8
    s_add_u32 s30, s30, s29
    s_mov_b32 s31, 0xbfb8aa3b
    v_accvgpr_read_b32 v8, a0
    v_accvgpr_read_b32 v12, a4
    v_accvgpr_read_b32 v9, a1
    v_accvgpr_read_b32 v13, a5
    v_accvgpr_read_b32 v10, a2
    v_accvgpr_read_b32 v14, a6
    v_accvgpr_read_b32 v11, a3
    v_accvgpr_read_b32 v15, a7
    v_mul_f32 v20, s31, v8
    v_mul_f32 v21, s31, v9
    v_mul_f32 v22, s31, v10
    v_mul_f32 v23, s31, v11
    v_exp_f32 v20, v20
    v_exp_f32 v21, v21
    v_exp_f32 v22, v22
    v_exp_f32 v23, v23
    s_nop 0
    v_add_f32 v20, 1.0, v20
    v_add_f32 v21, 1.0, v21
    v_add_f32 v22, 1.0, v22
    v_add_f32 v23, 1.0, v23
    v_rcp_f32 v20, v20
    v_rcp_f32 v21, v21
    v_rcp_f32 v22, v22
    v_rcp_f32 v23, v23
    s_nop 0
    v_mul_f32 v8, v8, v20
    v_mul_f32 v9, v9, v21
    v_mul_f32 v10, v10, v22
    v_mul_f32 v11, v11, v23
    v_mul_f32 v8, v8, v12
    v_mul_f32 v9, v9, v13
    v_mul_f32 v10, v10, v14
    v_mul_f32 v11, v11, v15
    v_cvt_pk_bf16_f32 v24, v8, v9
    v_cvt_pk_bf16_f32 v25, v10, v11
    buffer_store_dwordx2 v[24:25], v3, s[16:19], s30 offen offset:0
    s_nop 1
    v_accvgpr_read_b32 v8, a32
    v_accvgpr_read_b32 v12, a36
    v_accvgpr_read_b32 v9, a33
    v_accvgpr_read_b32 v13, a37
    v_accvgpr_read_b32 v10, a34
    v_accvgpr_read_b32 v14, a38
    v_accvgpr_read_b32 v11, a35
    v_accvgpr_read_b32 v15, a39
    v_mul_f32 v20, s31, v8
    v_mul_f32 v21, s31, v9
    v_mul_f32 v22, s31, v10
    v_mul_f32 v23, s31, v11
    v_exp_f32 v20, v20
    v_exp_f32 v21, v21
    v_exp_f32 v22, v22
    v_exp_f32 v23, v23
    s_nop 0
    v_add_f32 v20, 1.0, v20
    v_add_f32 v21, 1.0, v21
    v_add_f32 v22, 1.0, v22
    v_add_f32 v23, 1.0, v23
    v_rcp_f32 v20, v20
    v_rcp_f32 v21, v21
    v_rcp_f32 v22, v22
    v_rcp_f32 v23, v23
    s_nop 0
    v_mul_f32 v8, v8, v20
    v_mul_f32 v9, v9, v21
    v_mul_f32 v10, v10, v22
    v_mul_f32 v11, v11, v23
    v_mul_f32 v8, v8, v12
    v_mul_f32 v9, v9, v13
    v_mul_f32 v10, v10, v14
    v_mul_f32 v11, v11, v15
    v_cvt_pk_bf16_f32 v24, v8, v9
    v_cvt_pk_bf16_f32 v25, v10, v11
    buffer_store_dwordx2 v[24:25], v4, s[16:19], s30 offen offset:0
    s_nop 1
    v_accvgpr_read_b32 v8, a8
    v_accvgpr_read_b32 v12, a12
    v_accvgpr_read_b32 v9, a9
    v_accvgpr_read_b32 v13, a13
    v_accvgpr_read_b32 v10, a10
    v_accvgpr_read_b32 v14, a14
    v_accvgpr_read_b32 v11, a11
    v_accvgpr_read_b32 v15, a15
    v_mul_f32 v20, s31, v8
    v_mul_f32 v21, s31, v9
    v_mul_f32 v22, s31, v10
    v_mul_f32 v23, s31, v11
    v_exp_f32 v20, v20
    v_exp_f32 v21, v21
    v_exp_f32 v22, v22
    v_exp_f32 v23, v23
    s_nop 0
    v_add_f32 v20, 1.0, v20
    v_add_f32 v21, 1.0, v21
    v_add_f32 v22, 1.0, v22
    v_add_f32 v23, 1.0, v23
    v_rcp_f32 v20, v20
    v_rcp_f32 v21, v21
    v_rcp_f32 v22, v22
    v_rcp_f32 v23, v23
    s_nop 0
    v_mul_f32 v8, v8, v20
    v_mul_f32 v9, v9, v21
    v_mul_f32 v10, v10, v22
    v_mul_f32 v11, v11, v23
    v_mul_f32 v8, v8, v12
    v_mul_f32 v9, v9, v13
    v_mul_f32 v10, v10, v14
    v_mul_f32 v11, v11, v15
    v_cvt_pk_bf16_f32 v24, v8, v9
    v_cvt_pk_bf16_f32 v25, v10, v11
    buffer_store_dwordx2 v[24:25], v3, s[16:19], s30 offen offset:32
    s_nop 1
    v_accvgpr_read_b32 v8, a40
    v_accvgpr_read_b32 v12, a44
    v_accvgpr_read_b32 v9, a41
    v_accvgpr_read_b32 v13, a45
    v_accvgpr_read_b32 v10, a42
    v_accvgpr_read_b32 v14, a46
    v_accvgpr_read_b32 v11, a43
    v_accvgpr_read_b32 v15, a47
    v_mul_f32 v20, s31, v8
    v_mul_f32 v21, s31, v9
    v_mul_f32 v22, s31, v10
    v_mul_f32 v23, s31, v11
    v_exp_f32 v20, v20
    v_exp_f32 v21, v21
    v_exp_f32 v22, v22
    v_exp_f32 v23, v23
    s_nop 0
    v_add_f32 v20, 1.0, v20
    v_add_f32 v21, 1.0, v21
    v_add_f32 v22, 1.0, v22
    v_add_f32 v23, 1.0, v23
    v_rcp_f32 v20, v20
    v_rcp_f32 v21, v21
    v_rcp_f32 v22, v22
    v_rcp_f32 v23, v23
    s_nop 0
    v_mul_f32 v8, v8, v20
    v_mul_f32 v9, v9, v21
    v_mul_f32 v10, v10, v22
    v_mul_f32 v11, v11, v23
    v_mul_f32 v8, v8, v12
    v_mul_f32 v9, v9, v13
    v_mul_f32 v10, v10, v14
    v_mul_f32 v11, v11, v15
    v_cvt_pk_bf16_f32 v24, v8, v9
    v_cvt_pk_bf16_f32 v25, v10, v11
    buffer_store_dwordx2 v[24:25], v4, s[16:19], s30 offen offset:32
    s_nop 1
    v_accvgpr_read_b32 v8, a16
    v_accvgpr_read_b32 v12, a20
    v_accvgpr_read_b32 v9, a17
    v_accvgpr_read_b32 v13, a21
    v_accvgpr_read_b32 v10, a18
    v_accvgpr_read_b32 v14, a22
    v_accvgpr_read_b32 v11, a19
    v_accvgpr_read_b32 v15, a23
    v_mul_f32 v20, s31, v8
    v_mul_f32 v21, s31, v9
    v_mul_f32 v22, s31, v10
    v_mul_f32 v23, s31, v11
    v_exp_f32 v20, v20
    v_exp_f32 v21, v21
    v_exp_f32 v22, v22
    v_exp_f32 v23, v23
    s_nop 0
    v_add_f32 v20, 1.0, v20
    v_add_f32 v21, 1.0, v21
    v_add_f32 v22, 1.0, v22
    v_add_f32 v23, 1.0, v23
    v_rcp_f32 v20, v20
    v_rcp_f32 v21, v21
    v_rcp_f32 v22, v22
    v_rcp_f32 v23, v23
    s_nop 0
    v_mul_f32 v8, v8, v20
    v_mul_f32 v9, v9, v21
    v_mul_f32 v10, v10, v22
    v_mul_f32 v11, v11, v23
    v_mul_f32 v8, v8, v12
    v_mul_f32 v9, v9, v13
    v_mul_f32 v10, v10, v14
    v_mul_f32 v11, v11, v15
    v_cvt_pk_bf16_f32 v24, v8, v9
    v_cvt_pk_bf16_f32 v25, v10, v11
    buffer_store_dwordx2 v[24:25], v3, s[16:19], s30 offen offset:64
    s_nop 1
    v_accvgpr_read_b32 v8, a48
    v_accvgpr_read_b32 v12, a52
    v_accvgpr_read_b32 v9, a49
    v_accvgpr_read_b32 v13, a53
    v_accvgpr_read_b32 v10, a50
    v_accvgpr_read_b32 v14, a54
    v_accvgpr_read_b32 v11, a51
    v_accvgpr_read_b32 v15, a55
    v_mul_f32 v20, s31, v8
    v_mul_f32 v21, s31, v9
    v_mul_f32 v22, s31, v10
    v_mul_f32 v23, s31, v11
    v_exp_f32 v20, v20
    v_exp_f32 v21, v21
    v_exp_f32 v22, v22
    v_exp_f32 v23, v23
    s_nop 0
    v_add_f32 v20, 1.0, v20
    v_add_f32 v21, 1.0, v21
    v_add_f32 v22, 1.0, v22
    v_add_f32 v23, 1.0, v23
    v_rcp_f32 v20, v20
    v_rcp_f32 v21, v21
    v_rcp_f32 v22, v22
    v_rcp_f32 v23, v23
    s_nop 0
    v_mul_f32 v8, v8, v20
    v_mul_f32 v9, v9, v21
    v_mul_f32 v10, v10, v22
    v_mul_f32 v11, v11, v23
    v_mul_f32 v8, v8, v12
    v_mul_f32 v9, v9, v13
    v_mul_f32 v10, v10, v14
    v_mul_f32 v11, v11, v15
    v_cvt_pk_bf16_f32 v24, v8, v9
    v_cvt_pk_bf16_f32 v25, v10, v11
    buffer_store_dwordx2 v[24:25], v4, s[16:19], s30 offen offset:64
    s_nop 1
    v_accvgpr_read_b32 v8, a24
    v_accvgpr_read_b32 v12, a28
    v_accvgpr_read_b32 v9, a25
    v_accvgpr_read_b32 v13, a29
    v_accvgpr_read_b32 v10, a26
    v_accvgpr_read_b32 v14, a30
    v_accvgpr_read_b32 v11, a27
    v_accvgpr_read_b32 v15, a31
    v_mul_f32 v20, s31, v8
    v_mul_f32 v21, s31, v9
    v_mul_f32 v22, s31, v10
    v_mul_f32 v23, s31, v11
    v_exp_f32 v20, v20
    v_exp_f32 v21, v21
    v_exp_f32 v22, v22
    v_exp_f32 v23, v23
    s_nop 0
    v_add_f32 v20, 1.0, v20
    v_add_f32 v21, 1.0, v21
    v_add_f32 v22, 1.0, v22
    v_add_f32 v23, 1.0, v23
    v_rcp_f32 v20, v20
    v_rcp_f32 v21, v21
    v_rcp_f32 v22, v22
    v_rcp_f32 v23, v23
    s_nop 0
    v_mul_f32 v8, v8, v20
    v_mul_f32 v9, v9, v21
    v_mul_f32 v10, v10, v22
    v_mul_f32 v11, v11, v23
    v_mul_f32 v8, v8, v12
    v_mul_f32 v9, v9, v13
    v_mul_f32 v10, v10, v14
    v_mul_f32 v11, v11, v15
    v_cvt_pk_bf16_f32 v24, v8, v9
    v_cvt_pk_bf16_f32 v25, v10, v11
    buffer_store_dwordx2 v[24:25], v3, s[16:19], s30 offen offset:96
    s_nop 1
    v_accvgpr_read_b32 v8, a56
    v_accvgpr_read_b32 v12, a60
    v_accvgpr_read_b32 v9, a57
    v_accvgpr_read_b32 v13, a61
    v_accvgpr_read_b32 v10, a58
    v_accvgpr_read_b32 v14, a62
    v_accvgpr_read_b32 v11, a59
    v_accvgpr_read_b32 v15, a63
    v_mul_f32 v20, s31, v8
    v_mul_f32 v21, s31, v9
    v_mul_f32 v22, s31, v10
    v_mul_f32 v23, s31, v11
    v_exp_f32 v20, v20
    v_exp_f32 v21, v21
    v_exp_f32 v22, v22
    v_exp_f32 v23, v23
    s_nop 0
    v_add_f32 v20, 1.0, v20
    v_add_f32 v21, 1.0, v21
    v_add_f32 v22, 1.0, v22
    v_add_f32 v23, 1.0, v23
    v_rcp_f32 v20, v20
    v_rcp_f32 v21, v21
    v_rcp_f32 v22, v22
    v_rcp_f32 v23, v23
    s_nop 0
    v_mul_f32 v8, v8, v20
    v_mul_f32 v9, v9, v21
    v_mul_f32 v10, v10, v22
    v_mul_f32 v11, v11, v23
    v_mul_f32 v8, v8, v12
    v_mul_f32 v9, v9, v13
    v_mul_f32 v10, v10, v14
    v_mul_f32 v11, v11, v15
    v_cvt_pk_bf16_f32 v24, v8, v9
    v_cvt_pk_bf16_f32 v25, v10, v11
    buffer_store_dwordx2 v[24:25], v4, s[16:19], s30 offen offset:96
    s_nop 1
    s_waitcnt vmcnt(0)
k3_kernel_end:
    s_endpgm
.globl k4_kernel
.p2align 8
.type k4_kernel,@function
k4_kernel:
    s_load_dwordx2 s[4:5], s[0:1], 48
    s_load_dwordx2 s[6:7], s[0:1], 56
    s_load_dwordx2 s[20:21], s[0:1], 72
    s_cmp_ge_u32 s2, 224
    s_cbranch_scc1 k4_kernel_end
    v_lshrrev_b32 v2, 6, v0
    v_and_b32 v1, 63, v0
    s_nop 0
    v_readfirstlane_b32 s3, v2
    s_waitcnt lgkmcnt(0)
    s_add_u32 s8, s20, 0x800000
    s_addc_u32 s9, s21, 0
    s_mov_b32 s10, 0x700000
    s_mov_b32 s11, 0x00020000
    s_mov_b32 s12, s4
    s_mov_b32 s13, s5
    s_mov_b32 s14, 0x188000
    s_mov_b32 s15, 0x00020000
    s_mov_b32 s16, s6
    s_mov_b32 s17, s7
    s_mov_b32 s18, 0x1c0000
    s_mov_b32 s19, 0x00020000
    s_add_u32 s48, s20, 0x600000
    s_addc_u32 s49, s21, 0
    s_mov_b32 s50, 0x1c0000
    s_mov_b32 s51, 0x00020000
    s_and_b32 s24, s2, 7
    s_lshr_b32 s25, s2, 3
    s_mul_i32 s26, s25, 37
    s_lshr_b32 s26, s26, 8
    s_mul_i32 s27, s26, 7
    s_sub_u32 s27, s25, s27
    s_lshl_b32 s24, s24, 2
    s_add_u32 s24, s24, s26
    s_lshl_b32 s28, s24, 6
    s_lshr_b32 s34, s3, 2
    s_bfe_u32 s35, s3, 0x10001
    s_and_b32 s36, s3, 1
    s_and_b32 s37, s3, 3
    v_lshrrev_b32 v2, 3, v1
    v_and_b32 v3, 7, v1
    v_xor_b32 v4, v3, v2
    v_bfe_u32 v5, v1, 4, 1
    v_lshlrev_b32 v5, 2, v5
    v_xor_b32 v5, v3, v5
    v_mul_u32_u24 v6, 3584, v2
    v_lshl_add_u32 v6, v4, 4, v6
    v_mul_u32_u24 v7, 896, v2
    v_lshl_add_u32 v7, v5, 4, v7
    s_lshl_b32 s38, s37, 5
    s_add_u32 s38, s38, s28
    s_mul_i32 s38, s38, 3584
    s_mul_i32 s39, s34, 1792
    s_add_u32 s38, s38, s39
    s_sub_u32 s39, s37, 2
    s_lshl_b32 s39, s39, 5
    s_mul_i32 s40, s34, 896
    s_add_u32 s39, s39, s40
    s_mul_i32 s39, s39, 896
    s_lshl_b32 s40, s27, 7
    s_add_u32 s39, s39, s40
    s_lshl_b32 s41, s34, 14
    s_lshl_b32 s40, s37, 12
    s_add_u32 s41, s41, s40
    s_mov_b32 s45, 7168
    s_mov_b32 s46, 57344
    s_cmp_lt_u32 s37, 2
    s_cselect_b32 s60, s8, s12
    s_cselect_b32 s61, s9, s13
    s_cselect_b32 s62, s10, s14
    s_mov_b32 s63, 0x00020000
    s_cselect_b32 s42, s38, s39
    s_cselect_b32 s43, 28672, s45
    s_cselect_b32 s44, 128, s46
    s_cselect_b64 vcc, -1, 0
    s_nop 1
    v_cndmask_b32 v2, v7, v6, vcc
    s_mov_b32 s31, s42
    s_add_u32 s30, s41, 0
    s_mov_b32 m0, s30
    s_nop 0
    buffer_load_dwordx4 v2, s[60:63], s31 offen lds
    s_add_u32 s31, s31, s43
    s_add_u32 s30, s41, 1024
    s_mov_b32 m0, s30
    s_nop 0
    buffer_load_dwordx4 v2, s[60:63], s31 offen lds
    s_add_u32 s31, s31, s43
    s_add_u32 s30, s41, 2048
    s_mov_b32 m0, s30
    s_nop 0
    buffer_load_dwordx4 v2, s[60:63], s31 offen lds
    s_add_u32 s31, s31, s43
    s_add_u32 s30, s41, 3072
    s_mov_b32 m0, s30
    s_nop 0
    buffer_load_dwordx4 v2, s[60:63], s31 offen lds
    s_add_u32 s31, s31, s43
    s_add_u32 s42, s42, s44
    s_mov_b32 s31, s42
    s_add_u32 s30, s41, 32768
    s_mov_b32 m0, s30
    s_nop 0
    buffer_load_dwordx4 v2, s[60:63], s31 offen lds
    s_add_u32 s31, s31, s43
    s_add_u32 s30, s41, 33792
    s_mov_b32 m0, s30
    s_nop 0
    buffer_load_dwordx4 v2, s[60:63], s31 offen lds
    s_add_u32 s31, s31, s43
    s_add_u32 s30, s41, 34816
    s_mov_b32 m0, s30
    s_nop 0
    buffer_load_dwordx4 v2, s[60:63], s31 offen lds
    s_add_u32 s31, s31, s43
    s_add_u32 s30, s41, 35840
    s_mov_b32 m0, s30
    s_nop 0
    buffer_load_dwordx4 v2, s[60:63], s31 offen lds
    s_add_u32 s31, s31, s43
    s_add_u32 s42, s42, s44
    s_mov_b32 s31, s42
    s_add_u32 s30, s41, 65536
    s_mov_b32 m0, s30
    s_nop 0
    buffer_load_dwordx4 v2, s[60:63], s31 offen lds
    s_add_u32 s31, s31, s43
    s_add_u32 s30, s41, 66560
    s_mov_b32 m0, s30
    s_nop 0
    buffer_load_dwordx4 v2, s[60:63], s31 offen lds
    s_add_u32 s31, s31, s43
    s_add_u32 s30, s41, 67584
    s_mov_b32 m0, s30
    s_nop 0
    buffer_load_dwordx4 v2, s[60:63], s31 offen lds
    s_add_u32 s31, s31, s43
    s_add_u32 s30, s41, 68608
    s_mov_b32 m0, s30
    s_nop 0
    buffer_load_dwordx4 v2, s[60:63], s31 offen lds
    s_add_u32 s31, s31, s43
    s_add_u32 s42, s42, s44
    v_and_b32 v8, 31, v1
    v_lshrrev_b32 v9, 5, v1
    v_and_b32 v10, 7, v1
    s_lshl_b32 s30, s35, 12
    s_lshl_b32 s31, s34, 14
    s_add_u32 s30, s30, s31
    v_lshlrev_b32 v11, 7, v8
    v_add_u32 v11, s30, v11
    v_add_u32 v12, 0, v9
    v_xor_b32 v12, v12, v10
    v_lshl_add_u32 v20, v12, 4, v11
    v_add_u32 v24, 65536, v20
    v_add_u32 v12, 2, v9
    v_xor_b32 v12, v12, v10
    v_lshl_add_u32 v21, v12, 4, v11
    v_add_u32 v25, 65536, v21
    v_add_u32 v12, 4, v9
    v_xor_b32 v12, v12, v10
    v_lshl_add_u32 v22, v12, 4, v11
    v_add_u32 v26, 65536, v22
    v_add_u32 v12, 6, v9
    v_xor_b32 v12, v12, v10
    v_lshl_add_u32 v23, v12, 4, v11
    v_add_u32 v27, 65536, v23
    v_lshrrev_b32 v12, 5, v1
    v_bfe_u32 v13, v1, 2, 2
    v_lshl_add_u32 v12, v12, 3, v13
    v_lshlrev_b32 v12, 7, v12
    v_bfe_u32 v14, v1, 4, 1
    v_lshlrev_b32 v14, 5, v14
    v_and_b32 v15, 3, v1
    v_lshl_add_u32 v14, v15, 3, v14
    s_lshl_b32 s30, s36, 6
    v_add_u32 v14, s30, v14
    v_bfe_u32 v15, v1, 3, 1
    v_lshlrev_b32 v15, 6, v15
    v_xor_b32 v14, v14, v15
    s_add_u32 s31, s31, 8192
    v_add3_u32 v28, v12, v14, s31
    v_add_u32 v29, 65536, v28
    v_accvgpr_write_b32 a0, 0
    v_accvgpr_write_b32 a1, 0
    v_accvgpr_write_b32 a2, 0
    v_accvgpr_write_b32 a3, 0
    v_accvgpr_write_b32 a4, 0
    v_accvgpr_write_b32 a5, 0
    v_accvgpr_write_b32 a6, 0
    v_accvgpr_write_b32 a7, 0
    v_accvgpr_write_b32 a8, 0
    v_accvgpr_write_b32 a9, 0
    v_accvgpr_write_b32 a10, 0
    v_accvgpr_write_b32 a11, 0
    v_accvgpr_write_b32 a12, 0
    v_accvgpr_write_b32 a13, 0
    v_accvgpr_write_b32 a14, 0
    v_accvgpr_write_b32 a15, 0
    s_waitcnt vmcnt(8)
    s_barrier
    s_mov_b32 s31, s42
    s_add_u32 s30, s41, 98304
    s_mov_b32 m0, s30
    s_nop 0
    buffer_load_dwordx4 v2, s[60:63], s31 offen lds
    s_add_u32 s31, s31, s43
    s_add_u32 s30, s41, 99328
    s_mov_b32 m0, s30
    s_nop 0
    buffer_load_dwordx4 v2, s[60:63], s31 offen lds
    s_add_u32 s31, s31, s43
    s_add_u32 s30, s41, 100352
    s_mov_b32 m0, s30
    s_nop 0
    buffer_load_dwordx4 v2, s[60:63], s31 offen lds
    s_add_u32 s31, s31, s43
    s_add_u32 s30, s41, 101376
    s_mov_b32 m0, s30
    s_nop 0
    buffer_load_dwordx4 v2, s[60:63], s31 offen lds
    s_add_u32 s31, s31, s43
    s_add_u32 s42, s42, s44
    ds_read_b128 v[32:35], v20 offset:0
    ds_read_b64_tr_b16 v[48:49], v28 offset:0
    ds_read_b64_tr_b16 v[50:51], v28 offset:512
    ds_read_b128 v[36:39], v21 offset:0
    ds_read_b64_tr_b16 v[52:53], v28 offset:2048
    ds_read_b64_tr_b16 v[54:55], v28 offset:2560
    ds_read_b128 v[40:43], v22 offset:0
    ds_read_b64_tr_b16 v[56:57], v28 offset:4096
    ds_read_b64_tr_b16 v[58:59], v28 offset:4608
    ds_read_b128 v[44:47], v23 offset:0
    ds_read_b64_tr_b16 v[60:61], v28 offset:6144
    ds_read_b64_tr_b16 v[62:63], v28 offset:6656
    s_waitcnt lgkmcnt(9)
    v_mfma_f32_32x32x16_bf16 a[0:15], v[48:51], v[32:35], a[0:15]
    s_waitcnt lgkmcnt(6)
    v_mfma_f32_32x32x16_bf16 a[0:15], v[52:55], v[36:39], a[0:15]
    s_waitcnt lgkmcnt(3)
    v_mfma_f32_32x32x16_bf16 a[0:15], v[56:59], v[40:43], a[0:15]
    s_waitcnt lgkmcnt(0)
    v_mfma_f32_32x32x16_bf16 a[0:15], v[60:63], v[44:47], a[0:15]
    s_waitcnt vmcnt(8)
    s_barrier
    s_mov_b32 s31, s42
    s_add_u32 s30, s41, 0
    s_mov_b32 m0, s30
    s_nop 0
    buffer_load_dwordx4 v2, s[60:63], s31 offen lds
    s_add_u32 s31, s31, s43
    s_add_u32 s30, s41, 1024
    s_mov_b32 m0, s30
    s_nop 0
    buffer_load_dwordx4 v2, s[60:63], s31 offen lds
    s_add_u32 s31, s31, s43
    s_add_u32 s30, s41, 2048
    s_mov_b32 m0, s30
    s_nop 0
    buffer_load_dwordx4 v2, s[60:63], s31 offen lds
    s_add_u32 s31, s31, s43
    s_add_u32 s30, s41, 3072
    s_mov_b32 m0, s30
    s_nop 0
    buffer_load_dwordx4 v2, s[60:63], s31 offen lds
    s_add_u32 s31, s31, s43
    s_add_u32 s42, s42, s44
    ds_read_b128 v[32:35], v20 offset:32768
    ds_read_b64_tr_b16 v[48:49], v28 offset:32768
    ds_read_b64_tr_b16 v[50:51], v28 offset:33280
    ds_read_b128 v[36:39], v21 offset:32768
    ds_read_b64_tr_b16 v[52:53], v28 offset:34816
    ds_read_b64_tr_b16 v[54:55], v28 offset:35328
    ds_read_b128 v[40:43], v22 offset:32768
    ds_read_b64_tr_b16 v[56:57], v28 offset:36864
    ds_read_b64_tr_b16 v[58:59], v28 offset:37376
    ds_read_b128 v[44:47], v23 offset:32768
    ds_read_b64_tr_b16 v[60:61], v28 offset:38912
    ds_read_b64_tr_b16 v[62:63], v28 offset:39424
    s_waitcnt lgkmcnt(9)
    v_mfma_f32_32x32x16_bf16 a[0:15], v[48:51], v[32:35], a[0:15]
    s_waitcnt lgkmcnt(6)
    v_mfma_f32_32x32x16_bf16 a[0:15], v[52:55], v[36:39], a[0:15]
    s_waitcnt lgkmcnt(3)
    v_mfma_f32_32x32x16_bf16 a[0:15], v[56:59], v[40:43], a[0:15]
    s_waitcnt lgkmcnt(0)
    v_mfma_f32_32x32x16_bf16 a[0:15], v[60:63], v[44:47], a[0:15]
    s_waitcnt vmcnt(8)
    s_barrier
    s_mov_b32 s31, s42
    s_add_u32 s30, s41, 32768
    s_mov_b32 m0, s30
    s_nop 0
    buffer_load_dwordx4 v2, s[60:63], s31 offen lds
    s_add_u32 s31, s31, s43
    s_add_u32 s30, s41, 33792
    s_mov_b32 m0, s30
    s_nop 0
    buffer_load_dwordx4 v2, s[60:63], s31 offen lds
    s_add_u32 s31, s31, s43
    s_add_u32 s30, s41, 34816
    s_mov_b32 m0, s30
    s_nop 0
    buffer_load_dwordx4 v2, s[60:63], s31 offen lds
    s_add_u32 s31, s31, s43
    s_add_u32 s30, s41, 35840
    s_mov_b32 m0, s30
    s_nop 0
    buffer_load_dwordx4 v2, s[60:63], s31 offen lds
    s_add_u32 s31, s31, s43
    s_add_u32 s42, s42, s44
    ds_read_b128 v[32:35], v24 offset:0
    ds_read_b64_tr_b16 v[48:49], v29 offset:0
    ds_read_b64_tr_b16 v[50:51], v29 offset:512
    ds_read_b128 v[36:39], v25 offset:0
    ds_read_b64_tr_b16 v[52:53], v29 offset:2048
    ds_read_b64_tr_b16 v[54:55], v29 offset:2560
    ds_read_b128 v[40:43], v26 offset:0
    ds_read_b64_tr_b16 v[56:57], v29 offset:4096
    ds_read_b64_tr_b16 v[58:59], v29 offset:4608
    ds_read_b128 v[44:47], v27 offset:0
    ds_read_b64_tr_b16 v[60:61], v29 offset:6144
    ds_read_b64_tr_b16 v[62:63], v29 offset:6656
    s_waitcnt lgkmcnt(9)
    v_mfma_f32_32x32x16_bf16 a[0:15], v[48:51], v[32:35], a[0:15]
    s_waitcnt lgkmcnt(6)
    v_mfma_f32_32x32x16_bf16 a[0:15], v[52:55], v[36:39], a[0:15]
    s_waitcnt lgkmcnt(3)
    v_mfma_f32_32x32x16_bf16 a[0:15], v[56:59], v[40:43], a[0:15]
    s_waitcnt lgkmcnt(0)
    v_mfma_f32_32x32x16_bf16 a[0:15], v[60:63], v[44:47], a[0:15]
    s_waitcnt vmcnt(8)
    s_barrier
    s_mov_b32 s31, s42
    s_add_u32 s30, s41, 65536
    s_mov_b32 m0, s30
    s_nop 0
    buffer_load_dwordx4 v2, s[60:63], s31 offen lds
    s_add_u32 s31, s31, s43
    s_add_u32 s30, s41, 66560
    s_mov_b32 m0, s30
    s_nop 0
    buffer_load_dwordx4 v2, s[60:63], s31 offen lds
    s_add_u32 s31, s31, s43
    s_add_u32 s30, s41, 67584
    s_mov_b32 m0, s30
    s_nop 0
    buffer_load_dwordx4 v2, s[60:63], s31 offen lds
    s_add_u32 s31, s31, s43
    s_add_u32 s30, s41, 68608
    s_mov_b32 m0, s30
    s_nop 0
    buffer_load_dwordx4 v2, s[60:63], s31 offen lds
    s_add_u32 s31, s31, s43
    s_add_u32 s42, s42, s44
    ds_read_b128 v[32:35], v24 offset:32768
    ds_read_b64_tr_b16 v[48:49], v29 offset:32768
    ds_read_b64_tr_b16 v[50:51], v29 offset:33280
    ds_read_b128 v[36:39], v25 offset:32768
    ds_read_b64_tr_b16 v[52:53], v29 offset:34816
    ds_read_b64_tr_b16 v[54:55], v29 offset:35328
    ds_read_b128 v[40:43], v26 offset:32768
    ds_read_b64_tr_b16 v[56:57], v29 offset:36864
    ds_read_b64_tr_b16 v[58:59], v29 offset:37376
    ds_read_b128 v[44:47], v27 offset:32768
    ds_read_b64_tr_b16 v[60:61], v29 offset:38912
    ds_read_b64_tr_b16 v[62:63], v29 offset:39424
    s_waitcnt lgkmcnt(9)
    v_mfma_f32_32x32x16_bf16 a[0:15], v[48:51], v[32:35], a[0:15]
    s_waitcnt lgkmcnt(6)
    v_mfma_f32_32x32x16_bf16 a[0:15], v[52:55], v[36:39], a[0:15]
    s_waitcnt lgkmcnt(3)
    v_mfma_f32_32x32x16_bf16 a[0:15], v[56:59], v[40:43], a[0:15]
    s_waitcnt lgkmcnt(0)
    v_mfma_f32_32x32x16_bf16 a[0:15], v[60:63], v[44:47], a[0:15]
    s_waitcnt vmcnt(8)
    s_barrier
    s_mov_b32 s31, s42
    s_add_u32 s30, s41, 98304
    s_mov_b32 m0, s30
    s_nop 0
    buffer_load_dwordx4 v2, s[60:63], s31 offen lds
    s_add_u32 s31, s31, s43
    s_add_u32 s30, s41, 99328
    s_mov_b32 m0, s30
    s_nop 0
    buffer_load_dwordx4 v2, s[60:63], s31 offen lds
    s_add_u32 s31, s31, s43
    s_add_u32 s30, s41, 100352
    s_mov_b32 m0, s30
    s_nop 0
    buffer_load_dwordx4 v2, s[60:63], s31 offen lds
    s_add_u32 s31, s31, s43
    s_add_u32 s30, s41, 101376
    s_mov_b32 m0, s30
    s_nop 0
    buffer_load_dwordx4 v2, s[60:63], s31 offen lds
    s_add_u32 s31, s31, s43
    s_add_u32 s42, s42, s44
    ds_read_b128 v[32:35], v20 offset:0
    ds_read_b64_tr_b16 v[48:49], v28 offset:0
    ds_read_b64_tr_b16 v[50:51], v28 offset:512
    ds_read_b128 v[36:39], v21 offset:0
    ds_read_b64_tr_b16 v[52:53], v28 offset:2048
    ds_read_b64_tr_b16 v[54:55], v28 offset:2560
    ds_read_b128 v[40:43], v22 offset:0
    ds_read_b64_tr_b16 v[56:57], v28 offset:4096
    ds_read_b64_tr_b16 v[58:59], v28 offset:4608
    ds_read_b128 v[44:47], v23 offset:0
    ds_read_b64_tr_b16 v[60:61], v28 offset:6144
    ds_read_b64_tr_b16 v[62:63], v28 offset:6656
    s_waitcnt lgkmcnt(9)
    v_mfma_f32_32x32x16_bf16 a[0:15], v[48:51], v[32:35], a[0:15]
    s_waitcnt lgkmcnt(6)
    v_mfma_f32_32x32x16_bf16 a[0:15], v[52:55], v[36:39], a[0:15]
    s_waitcnt lgkmcnt(3)
    v_mfma_f32_32x32x16_bf16 a[0:15], v[56:59], v[40:43], a[0:15]
    s_waitcnt lgkmcnt(0)
    v_mfma_f32_32x32x16_bf16 a[0:15], v[60:63], v[44:47], a[0:15]
    s_waitcnt vmcnt(8)
    s_barrier
    s_mov_b32 s31, s42
    s_add_u32 s30, s41, 0
    s_mov_b32 m0, s30
    s_nop 0
    buffer_load_dwordx4 v2, s[60:63], s31 offen lds
    s_add_u32 s31, s31, s43
    s_add_u32 s30, s41, 1024
    s_mov_b32 m0, s30
    s_nop 0
    buffer_load_dwordx4 v2, s[60:63], s31 offen lds
    s_add_u32 s31, s31, s43
    s_add_u32 s30, s41, 2048
    s_mov_b32 m0, s30
    s_nop 0
    buffer_load_dwordx4 v2, s[60:63], s31 offen lds
    s_add_u32 s31, s31, s43
    s_add_u32 s30, s41, 3072
    s_mov_b32 m0, s30
    s_nop 0
    buffer_load_dwordx4 v2, s[60:63], s31 offen lds
    s_add_u32 s31, s31, s43
    s_add_u32 s42, s42, s44
    ds_read_b128 v[32:35], v20 offset:32768
    ds_read_b64_tr_b16 v[48:49], v28 offset:32768
    ds_read_b64_tr_b16 v[50:51], v28 offset:33280
    ds_read_b128 v[36:39], v21 offset:32768
    ds_read_b64_tr_b16 v[52:53], v28 offset:34816
    ds_read_b64_tr_b16 v[54:55], v28 offset:35328
    ds_read_b128 v[40:43], v22 offset:32768
    ds_read_b64_tr_b16 v[56:57], v28 offset:36864
    ds_read_b64_tr_b16 v[58:59], v28 offset:37376
    ds_read_b128 v[44:47], v23 offset:32768
    ds_read_b64_tr_b16 v[60:61], v28 offset:38912
    ds_read_b64_tr_b16 v[62:63], v28 offset:39424
    s_waitcnt lgkmcnt(9)
    v_mfma_f32_32x32x16_bf16 a[0:15], v[48:51], v[32:35], a[0:15]
    s_waitcnt lgkmcnt(6)
    v_mfma_f32_32x32x16_bf16 a[0:15], v[52:55], v[36:39], a[0:15]
    s_waitcnt lgkmcnt(3)
    v_mfma_f32_32x32x16_bf16 a[0:15], v[56:59], v[40:43], a[0:15]
    s_waitcnt lgkmcnt(0)
    v_mfma_f32_32x32x16_bf16 a[0:15], v[60:63], v[44:47], a[0:15]
    s_waitcnt vmcnt(8)
    s_barrier
    s_mov_b32 s31, s42
    s_add_u32 s30, s41, 32768
    s_mov_b32 m0, s30
    s_nop 0
    buffer_load_dwordx4 v2, s[60:63], s31 offen lds
    s_add_u32 s31, s31, s43
    s_add_u32 s30, s41, 33792
    s_mov_b32 m0, s30
    s_nop 0
    buffer_load_dwordx4 v2, s[60:63], s31 offen lds
    s_add_u32 s31, s31, s43
    s_add_u32 s30, s41, 34816
    s_mov_b32 m0, s30
    s_nop 0
    buffer_load_dwordx4 v2, s[60:63], s31 offen lds
    s_add_u32 s31, s31, s43
    s_add_u32 s30, s41, 35840
    s_mov_b32 m0, s30
    s_nop 0
    buffer_load_dwordx4 v2, s[60:63], s31 offen lds
    s_add_u32 s31, s31, s43
    s_add_u32 s42, s42, s44
    ds_read_b128 v[32:35], v24 offset:0
    ds_read_b64_tr_b16 v[48:49], v29 offset:0
    ds_read_b64_tr_b16 v[50:51], v29 offset:512
    ds_read_b128 v[36:39], v25 offset:0
    ds_read_b64_tr_b16 v[52:53], v29 offset:2048
    ds_read_b64_tr_b16 v[54:55], v29 offset:2560
    ds_read_b128 v[40:43], v26 offset:0
    ds_read_b64_tr_b16 v[56:57], v29 offset:4096
    ds_read_b64_tr_b16 v[58:59], v29 offset:4608
    ds_read_b128 v[44:47], v27 offset:0
    ds_read_b64_tr_b16 v[60:61], v29 offset:6144
    ds_read_b64_tr_b16 v[62:63], v29 offset:6656
    s_waitcnt lgkmcnt(9)
    v_mfma_f32_32x32x16_bf16 a[0:15], v[48:51], v[32:35], a[0:15]
    s_waitcnt lgkmcnt(6)
    v_mfma_f32_32x32x16_bf16 a[0:15], v[52:55], v[36:39], a[0:15]
    s_waitcnt lgkmcnt(3)
    v_mfma_f32_32x32x16_bf16 a[0:15], v[56:59], v[40:43], a[0:15]
    s_waitcnt lgkmcnt(0)
    v_mfma_f32_32x32x16_bf16 a[0:15], v[60:63], v[44:47], a[0:15]
    s_waitcnt vmcnt(8)
    s_barrier
    s_mov_b32 s31, s42
    s_add_u32 s30, s41, 65536
    s_mov_b32 m0, s30
    s_nop 0
    buffer_load_dwordx4 v2, s[60:63], s31 offen lds
    s_add_u32 s31, s31, s43
    s_add_u32 s30, s41, 66560
    s_mov_b32 m0, s30
    s_nop 0
    buffer_load_dwordx4 v2, s[60:63], s31 offen lds
    s_add_u32 s31, s31, s43
    s_add_u32 s30, s41, 67584
    s_mov_b32 m0, s30
    s_nop 0
    buffer_load_dwordx4 v2, s[60:63], s31 offen lds
    s_add_u32 s31, s31, s43
    s_add_u32 s30, s41, 68608
    s_mov_b32 m0, s30
    s_nop 0
    buffer_load_dwordx4 v2, s[60:63], s31 offen lds
    s_add_u32 s31, s31, s43
    s_add_u32 s42, s42, s44
    ds_read_b128 v[32:35], v24 offset:32768
    ds_read_b64_tr_b16 v[48:49], v29 offset:32768
    ds_read_b64_tr_b16 v[50:51], v29 offset:33280
    ds_read_b128 v[36:39], v25 offset:32768
    ds_read_b64_tr_b16 v[52:53], v29 offset:34816
    ds_read_b64_tr_b16 v[54:55], v29 offset:35328
    ds_read_b128 v[40:43], v26 offset:32768
    ds_read_b64_tr_b16 v[56:57], v29 offset:36864
    ds_read_b64_tr_b16 v[58:59], v29 offset:37376
    ds_read_b128 v[44:47], v27 offset:32768
    ds_read_b64_tr_b16 v[60:61], v29 offset:38912
    ds_read_b64_tr_b16 v[62:63], v29 offset:39424
    s_waitcnt lgkmcnt(9)
    v_mfma_f32_32x32x16_bf16 a[0:15], v[48:51], v[32:35], a[0:15]
    s_waitcnt lgkmcnt(6)
    v_mfma_f32_32x32x16_bf16 a[0:15], v[52:55], v[36:39], a[0:15]
    s_waitcnt lgkmcnt(3)
    v_mfma_f32_32x32x16_bf16 a[0:15], v[56:59], v[40:43], a[0:15]
    s_waitcnt lgkmcnt(0)
    v_mfma_f32_32x32x16_bf16 a[0:15], v[60:63], v[44:47], a[0:15]
    s_waitcnt vmcnt(8)
    s_barrier
    s_mov_b32 s31, s42
    s_add_u32 s30, s41, 98304
    s_mov_b32 m0, s30
    s_nop 0
    buffer_load_dwordx4 v2, s[60:63], s31 offen lds
    s_add_u32 s31, s31, s43
    s_add_u32 s30, s41, 99328
    s_mov_b32 m0, s30
    s_nop 0
    buffer_load_dwordx4 v2, s[60:63], s31 offen lds
    s_add_u32 s31, s31, s43
    s_add_u32 s30, s41, 100352
    s_mov_b32 m0, s30
    s_nop 0
    buffer_load_dwordx4 v2, s[60:63], s31 offen lds
    s_add_u32 s31, s31, s43
    s_add_u32 s30, s41, 101376
    s_mov_b32 m0, s30
    s_nop 0
    buffer_load_dwordx4 v2, s[60:63], s31 offen lds
    s_add_u32 s31, s31, s43
    s_add_u32 s42, s42, s44
    ds_read_b128 v[32:35], v20 offset:0
    ds_read_b64_tr_b16 v[48:49], v28 offset:0
    ds_read_b64_tr_b16 v[50:51], v28 offset:512
    ds_read_b128 v[36:39], v21 offset:0
    ds_read_b64_tr_b16 v[52:53], v28 offset:2048
    ds_read_b64_tr_b16 v[54:55], v28 offset:2560
    ds_read_b128 v[40:43], v22 offset:0
    ds_read_b64_tr_b16 v[56:57], v28 offset:4096
    ds_read_b64_tr_b16 v[58:59], v28 offset:4608
    ds_read_b128 v[44:47], v23 offset:0
    ds_read_b64_tr_b16 v[60:61], v28 offset:6144
    ds_read_b64_tr_b16 v[62:63], v28 offset:6656
    s_waitcnt lgkmcnt(9)
    v_mfma_f32_32x32x16_bf16 a[0:15], v[48:51], v[32:35], a[0:15]
    s_waitcnt lgkmcnt(6)
    v_mfma_f32_32x32x16_bf16 a[0:15], v[52:55], v[36:39], a[0:15]
    s_waitcnt lgkmcnt(3)
    v_mfma_f32_32x32x16_bf16 a[0:15], v[56:59], v[40:43], a[0:15]
    s_waitcnt lgkmcnt(0)
    v_mfma_f32_32x32x16_bf16 a[0:15], v[60:63], v[44:47], a[0:15]
    s_waitcnt vmcnt(8)
    s_barrier
    s_mov_b32 s31, s42
    s_add_u32 s30, s41, 0
    s_mov_b32 m0, s30
    s_nop 0
    buffer_load_dwordx4 v2, s[60:63], s31 offen lds
    s_add_u32 s31, s31, s43
    s_add_u32 s30, s41, 1024
    s_mov_b32 m0, s30
    s_nop 0
    buffer_load_dwordx4 v2, s[60:63], s31 offen lds
    s_add_u32 s31, s31, s43
    s_add_u32 s30, s41, 2048
    s_mov_b32 m0, s30
    s_nop 0
    buffer_load_dwordx4 v2, s[60:63], s31 offen lds
    s_add_u32 s31, s31, s43
    s_add_u32 s30, s41, 3072
    s_mov_b32 m0, s30
    s_nop 0
    buffer_load_dwordx4 v2, s[60:63], s31 offen lds
    s_add_u32 s31, s31, s43
    s_add_u32 s42, s42, s44
    ds_read_b128 v[32:35], v20 offset:32768
    ds_read_b64_tr_b16 v[48:49], v28 offset:32768
    ds_read_b64_tr_b16 v[50:51], v28 offset:33280
    ds_read_b128 v[36:39], v21 offset:32768
    ds_read_b64_tr_b16 v[52:53], v28 offset:34816
    ds_read_b64_tr_b16 v[54:55], v28 offset:35328
    ds_read_b128 v[40:43], v22 offset:32768
    ds_read_b64_tr_b16 v[56:57], v28 offset:36864
    ds_read_b64_tr_b16 v[58:59], v28 offset:37376
    ds_read_b128 v[44:47], v23 offset:32768
    ds_read_b64_tr_b16 v[60:61], v28 offset:38912
    ds_read_b64_tr_b16 v[62:63], v28 offset:39424
    s_waitcnt lgkmcnt(9)
    v_mfma_f32_32x32x16_bf16 a[0:15], v[48:51], v[32:35], a[0:15]
    s_waitcnt lgkmcnt(6)
    v_mfma_f32_32x32x16_bf16 a[0:15], v[52:55], v[36:39], a[0:15]
    s_waitcnt lgkmcnt(3)
    v_mfma_f32_32x32x16_bf16 a[0:15], v[56:59], v[40:43], a[0:15]
    s_waitcnt lgkmcnt(0)
    v_mfma_f32_32x32x16_bf16 a[0:15], v[60:63], v[44:47], a[0:15]
    s_waitcnt vmcnt(8)
    s_barrier
    s_mov_b32 s31, s42
    s_add_u32 s30, s41, 32768
    s_mov_b32 m0, s30
    s_nop 0
    buffer_load_dwordx4 v2, s[60:63], s31 offen lds
    s_add_u32 s31, s31, s43
    s_add_u32 s30, s41, 33792
    s_mov_b32 m0, s30
    s_nop 0
    buffer_load_dwordx4 v2, s[60:63], s31 offen lds
    s_add_u32 s31, s31, s43
    s_add_u32 s30, s41, 34816
    s_mov_b32 m0, s30
    s_nop 0
    buffer_load_dwordx4 v2, s[60:63], s31 offen lds
    s_add_u32 s31, s31, s43
    s_add_u32 s30, s41, 35840
    s_mov_b32 m0, s30
    s_nop 0
    buffer_load_dwordx4 v2, s[60:63], s31 offen lds
    s_add_u32 s31, s31, s43
    s_add_u32 s42, s42, s44
    ds_read_b128 v[32:35], v24 offset:0
    ds_read_b64_tr_b16 v[48:49], v29 offset:0
    ds_read_b64_tr_b16 v[50:51], v29 offset:512
    ds_read_b128 v[36:39], v25 offset:0
    ds_read_b64_tr_b16 v[52:53], v29 offset:2048
    ds_read_b64_tr_b16 v[54:55], v29 offset:2560
    ds_read_b128 v[40:43], v26 offset:0
    ds_read_b64_tr_b16 v[56:57], v29 offset:4096
    ds_read_b64_tr_b16 v[58:59], v29 offset:4608
    ds_read_b128 v[44:47], v27 offset:0
    ds_read_b64_tr_b16 v[60:61], v29 offset:6144
    ds_read_b64_tr_b16 v[62:63], v29 offset:6656
    s_waitcnt lgkmcnt(9)
    v_mfma_f32_32x32x16_bf16 a[0:15], v[48:51], v[32:35], a[0:15]
    s_waitcnt lgkmcnt(6)
    v_mfma_f32_32x32x16_bf16 a[0:15], v[52:55], v[36:39], a[0:15]
    s_waitcnt lgkmcnt(3)
    v_mfma_f32_32x32x16_bf16 a[0:15], v[56:59], v[40:43], a[0:15]
    s_waitcnt lgkmcnt(0)
    v_mfma_f32_32x32x16_bf16 a[0:15], v[60:63], v[44:47], a[0:15]
    s_waitcnt vmcnt(8)
    s_barrier
    ds_read_b128 v[32:35], v24 offset:32768
    ds_read_b64_tr_b16 v[48:49], v29 offset:32768
    ds_read_b64_tr_b16 v[50:51], v29 offset:33280
    ds_read_b128 v[36:39], v25 offset:32768
    ds_read_b64_tr_b16 v[52:53], v29 offset:34816
    ds_read_b64_tr_b16 v[54:55], v29 offset:35328
    ds_read_b128 v[40:43], v26 offset:32768
    ds_read_b64_tr_b16 v[56:57], v29 offset:36864
    ds_read_b64_tr_b16 v[58:59], v29 offset:37376
    ds_read_b128 v[44:47], v27 offset:32768
    ds_read_b64_tr_b16 v[60:61], v29 offset:38912
    ds_read_b64_tr_b16 v[62:63], v29 offset:39424
    s_waitcnt lgkmcnt(9)
    v_mfma_f32_32x32x16_bf16 a[0:15], v[48:51], v[32:35], a[0:15]
    s_waitcnt lgkmcnt(6)
    v_mfma_f32_32x32x16_bf16 a[0:15], v[52:55], v[36:39], a[0:15]
    s_waitcnt lgkmcnt(3)
    v_mfma_f32_32x32x16_bf16 a[0:15], v[56:59], v[40:43], a[0:15]
    s_waitcnt lgkmcnt(0)
    v_mfma_f32_32x32x16_bf16 a[0:15], v[60:63], v[44:47], a[0:15]
    s_waitcnt vmcnt(4)
    s_barrier
    ds_read_b128 v[32:35], v20 offset:0
    ds_read_b64_tr_b16 v[48:49], v28 offset:0
    ds_read_b64_tr_b16 v[50:51], v28 offset:512
    ds_read_b128 v[36:39], v21 offset:0
    ds_read_b64_tr_b16 v[52:53], v28 offset:2048
    ds_read_b64_tr_b16 v[54:55], v28 offset:2560
    ds_read_b128 v[40:43], v22 offset:0
    ds_read_b64_tr_b16 v[56:57], v28 offset:4096
    ds_read_b64_tr_b16 v[58:59], v28 offset:4608
    ds_read_b128 v[44:47], v23 offset:0
    ds_read_b64_tr_b16 v[60:61], v28 offset:6144
    ds_read_b64_tr_b16 v[62:63], v28 offset:6656
    s_waitcnt lgkmcnt(9)
    v_mfma_f32_32x32x16_bf16 a[0:15], v[48:51], v[32:35], a[0:15]
    s_waitcnt lgkmcnt(6)
    v_mfma_f32_32x32x16_bf16 a[0:15], v[52:55], v[36:39], a[0:15]
    s_waitcnt lgkmcnt(3)
    v_mfma_f32_32x32x16_bf16 a[0:15], v[56:59], v[40:43], a[0:15]
    s_waitcnt lgkmcnt(0)
    v_mfma_f32_32x32x16_bf16 a[0:15], v[60:63], v[44:47], a[0:15]
    s_waitcnt vmcnt(0)
    s_barrier
    ds_read_b128 v[32:35], v20 offset:32768
    ds_read_b64_tr_b16 v[48:49], v28 offset:32768
    ds_read_b64_tr_b16 v[50:51], v28 offset:33280
    ds_read_b128 v[36:39], v21 offset:32768
    ds_read_b64_tr_b16 v[52:53], v28 offset:34816
    ds_read_b64_tr_b16 v[54:55], v28 offset:35328
    ds_read_b128 v[40:43], v22 offset:32768
    ds_read_b64_tr_b16 v[56:57], v28 offset:36864
    ds_read_b64_tr_b16 v[58:59], v28 offset:37376
    ds_read_b128 v[44:47], v23 offset:32768
    ds_read_b64_tr_b16 v[60:61], v28 offset:38912
    ds_read_b64_tr_b16 v[62:63], v28 offset:39424
    s_waitcnt lgkmcnt(9)
    v_mfma_f32_32x32x16_bf16 a[0:15], v[48:51], v[32:35], a[0:15]
    s_waitcnt lgkmcnt(6)
    v_mfma_f32_32x32x16_bf16 a[0:15], v[52:55], v[36:39], a[0:15]
    s_waitcnt lgkmcnt(3)
    v_mfma_f32_32x32x16_bf16 a[0:15], v[56:59], v[40:43], a[0:15]
    s_waitcnt lgkmcnt(0)
    v_mfma_f32_32x32x16_bf16 a[0:15], v[60:63], v[44:47], a[0:15]
    s_nop 15
    s_nop 3
    s_barrier
    v_lshlrev_b32 v10, 2, v1
    s_lshl_b32 s30, s37, 12
    v_add_u32 v10, s30, v10
    s_cmp_eq_u32 s34, 0
    s_cbranch_scc1 k4_kernel_rd
    v_accvgpr_read_b32 v12, a0
    ds_write_b32 v10, v12 offset:0
    v_accvgpr_read_b32 v12, a1
    ds_write_b32 v10, v12 offset:256
    v_accvgpr_read_b32 v12, a2
    ds_write_b32 v10, v12 offset:512
    v_accvgpr_read_b32 v12, a3
    ds_write_b32 v10, v12 offset:768
    v_accvgpr_read_b32 v12, a4
    ds_write_b32 v10, v12 offset:1024
    v_accvgpr_read_b32 v12, a5
    ds_write_b32 v10, v12 offset:1280
    v_accvgpr_read_b32 v12, a6
    ds_write_b32 v10, v12 offset:1536
    v_accvgpr_read_b32 v12, a7
    ds_write_b32 v10, v12 offset:1792
    v_accvgpr_read_b32 v12, a8
    ds_write_b32 v10, v12 offset:2048
    v_accvgpr_read_b32 v12, a9
    ds_write_b32 v10, v12 offset:2304
    v_accvgpr_read_b32 v12, a10
    ds_write_b32 v10, v12 offset:2560
    v_accvgpr_read_b32 v12, a11
    ds_write_b32 v10, v12 offset:2816
    v_accvgpr_read_b32 v12, a12
    ds_write_b32 v10, v12 offset:3072
    v_accvgpr_read_b32 v12, a13
    ds_write_b32 v10, v12 offset:3328
    v_accvgpr_read_b32 v12, a14
    ds_write_b32 v10, v12 offset:3584
    v_accvgpr_read_b32 v12, a15
    ds_write_b32 v10, v12 offset:3840
    s_waitcnt lgkmcnt(0)
    s_barrier
    s_branch k4_kernel_end
k4_kernel_rd:
    s_lshl_b32 s30, s35, 5
    s_add_u32 s30, s30, s28
    v_and_b32 v13, 31, v1
    v_add_u32 v13, s30, v13
    v_mul_u32_u24 v13, 896, v13
    v_lshrrev_b32 v14, 5, v1
    v_lshl_add_u32 v13, v14, 3, v13
    s_lshl_b32 s30, s36, 6
    s_lshl_b32 s31, s27, 7
    s_add_u32 s30, s30, s31
    v_add_u32 v13, s30, v13
    buffer_load_dwordx2 v[24:25], v13, s[48:51], 0 offen offset:0
    buffer_load_dwordx2 v[26:27], v13, s[48:51], 0 offen offset:16
    buffer_load_dwordx2 v[28:29], v13, s[48:51], 0 offen offset:32
    buffer_load_dwordx2 v[30:31], v13, s[48:51], 0 offen offset:48
    s_barrier
    ds_read_b32 v32, v10 offset:0
    ds_read_b32 v33, v10 offset:256
    ds_read_b32 v34, v10 offset:512
    ds_read_b32 v35, v10 offset:768
    ds_read_b32 v36, v10 offset:1024
    ds_read_b32 v37, v10 offset:1280
    ds_read_b32 v38, v10 offset:1536
    ds_read_b32 v39, v10 offset:1792
    ds_read_b32 v40, v10 offset:2048
    ds_read_b32 v41, v10 offset:2304
    ds_read_b32 v42, v10 offset:2560
    ds_read_b32 v43, v10 offset:2816
    ds_read_b32 v44, v10 offset:3072
    ds_read_b32 v45, v10 offset:3328
    ds_read_b32 v46, v10 offset:3584
    ds_read_b32 v47, v10 offset:3840
    s_waitcnt lgkmcnt(0) vmcnt(0)
    v_accvgpr_read_b32 v48, a0
    v_add_f32 v48, v48, v32
    v_accvgpr_read_b32 v49, a1
    v_add_f32 v49, v49, v33
    v_accvgpr_read_b32 v50, a2
    v_add_f32 v50, v50, v34
    v_accvgpr_read_b32 v51, a3
    v_add_f32 v51, v51, v35
    v_lshlrev_b32 v52, 16, v24
    v_and_b32 v53, 0xffff0000, v24
    v_lshlrev_b32 v54, 16, v25
    v_and_b32 v55, 0xffff0000, v25
    v_add_f32 v48, v48, v52
    v_add_f32 v49, v49, v53
    v_add_f32 v50, v50, v54
    v_add_f32 v51, v51, v55
    v_cvt_pk_bf16_f32 v56, v48, v49
    v_cvt_pk_bf16_f32 v57, v50, v51
    buffer_store_dwordx2 v[56:57], v13, s[16:19], 0 offen offset:0
    s_nop 1
    v_accvgpr_read_b32 v48, a4
    v_add_f32 v48, v48, v36
    v_accvgpr_read_b32 v49, a5
    v_add_f32 v49, v49, v37
    v_accvgpr_read_b32 v50, a6
    v_add_f32 v50, v50, v38
    v_accvgpr_read_b32 v51, a7
    v_add_f32 v51, v51, v39
    v_lshlrev_b32 v52, 16, v26
    v_and_b32 v53, 0xffff0000, v26
    v_lshlrev_b32 v54, 16, v27
    v_and_b32 v55, 0xffff0000, v27
    v_add_f32 v48, v48, v52
    v_add_f32 v49, v49, v53
    v_add_f32 v50, v50, v54
    v_add_f32 v51, v51, v55
    v_cvt_pk_bf16_f32 v56, v48, v49
    v_cvt_pk_bf16_f32 v57, v50, v51
    buffer_store_dwordx2 v[56:57], v13, s[16:19], 0 offen offset:16
    s_nop 1
    v_accvgpr_read_b32 v48, a8
    v_add_f32 v48, v48, v40
    v_accvgpr_read_b32 v49, a9
    v_add_f32 v49, v49, v41
    v_accvgpr_read_b32 v50, a10
    v_add_f32 v50, v50, v42
    v_accvgpr_read_b32 v51, a11
    v_add_f32 v51, v51, v43
    v_lshlrev_b32 v52, 16, v28
    v_and_b32 v53, 0xffff0000, v28
    v_lshlrev_b32 v54, 16, v29
    v_and_b32 v55, 0xffff0000, v29
    v_add_f32 v48, v48, v52
    v_add_f32 v49, v49, v53
    v_add_f32 v50, v50, v54
    v_add_f32 v51, v51, v55
    v_cvt_pk_bf16_f32 v56, v48, v49
    v_cvt_pk_bf16_f32 v57, v50, v51
    buffer_store_dwordx2 v[56:57], v13, s[16:19], 0 offen offset:32
    s_nop 1
    v_accvgpr_read_b32 v48, a12
    v_add_f32 v48, v48, v44
    v_accvgpr_read_b32 v49, a13
    v_add_f32 v49, v49, v45
    v_accvgpr_read_b32 v50, a14
    v_add_f32 v50, v50, v46
    v_accvgpr_read_b32 v51, a15
    v_add_f32 v51, v51, v47
    v_lshlrev_b32 v52, 16, v30
    v_and_b32 v53, 0xffff0000, v30
    v_lshlrev_b32 v54, 16, v31
    v_and_b32 v55, 0xffff0000, v31
    v_add_f32 v48, v48, v52
    v_add_f32 v49, v49, v53
    v_add_f32 v50, v50, v54
    v_add_f32 v51, v51, v55
    v_cvt_pk_bf16_f32 v56, v48, v49
    v_cvt_pk_bf16_f32 v57, v50, v51
    buffer_store_dwordx2 v[56:57], v13, s[16:19], 0 offen offset:48
    s_nop 1
k4_kernel_end:
    s_endpgm
.section .rodata,"a"
.p2align 6
.amdhsa_kernel k1_kernel
  .amdhsa_next_free_vgpr 184
  .amdhsa_next_free_sgpr 64
  .amdhsa_accum_offset 160
  .amdhsa_group_segment_fixed_size 0
  .amdhsa_kernarg_size 80
  .amdhsa_user_sgpr_count 2
  .amdhsa_user_sgpr_kernarg_segment_ptr 1
  .amdhsa_system_sgpr_workgroup_id_x 1
.end_amdhsa_kernel
.p2align 6
.amdhsa_kernel k2_kernel
  .amdhsa_next_free_vgpr 168
  .amdhsa_next_free_sgpr 64
  .amdhsa_accum_offset 112
  .amdhsa_group_segment_fixed_size 0
  .amdhsa_kernarg_size 80
  .amdhsa_user_sgpr_count 2
  .amdhsa_user_sgpr_kernarg_segment_ptr 1
  .amdhsa_system_sgpr_workgroup_id_x 1
.end_amdhsa_kernel
.p2align 6
.amdhsa_kernel k3_kernel
  .amdhsa_next_free_vgpr 224
  .amdhsa_next_free_sgpr 64
  .amdhsa_accum_offset 160
  .amdhsa_group_segment_fixed_size 0
  .amdhsa_kernarg_size 80
  .amdhsa_user_sgpr_count 2
  .amdhsa_user_sgpr_kernarg_segment_ptr 1
  .amdhsa_system_sgpr_workgroup_id_x 1
.end_amdhsa_kernel
.p2align 6
.amdhsa_kernel k4_kernel
  .amdhsa_next_free_vgpr 80
  .amdhsa_next_free_sgpr 64
  .amdhsa_accum_offset 64
  .amdhsa_group_segment_fixed_size 0
  .amdhsa_kernarg_size 80
  .amdhsa_user_sgpr_count 2
  .amdhsa_user_sgpr_kernarg_segment_ptr 1
  .amdhsa_system_sgpr_workgroup_id_x 1
.end_amdhsa_kernel
```
